```python
import torch

def _softmax(x, axis=-1):
    return torch.softmax(x, dim=axis)
def _gelu(x):
    return torch.nn.functional.gelu(x, approximate="tanh")
def _silu(x):
    return torch.nn.functional.silu(x)
def _sigmoid(x):
    return torch.sigmoid(x)
def _layernorm(x, axis=-1, eps=1e-5):
    m = x.mean(dim=axis, keepdim=True)
    v = x.var(dim=axis, keepdim=True, unbiased=False)
    return (x - m) / torch.sqrt(v + eps)
def _scatter_add(tgt, idx, src, axis=0):
    return tgt.clone().index_add_(axis, idx, src)
def _segment_sum(src, seg, n):
    out = torch.zeros((n,) + src.shape[1:], dtype=src.dtype)
    return out.index_add_(0, seg, src)
def _pad(x, pw):
    flat = tuple(v for pair in reversed(pw) for v in pair)
    return torch.nn.functional.pad(x, flat)

kernel_name = 'sequential_preLN__spectral_gfnet__geglu_ffn__prompt'

def setup_inputs():

    _w = (lambda a: (lambda t: t.to(torch.bfloat16) if t.is_floating_point() else t)(torch.as_tensor(a)))
    def _A_setup():
        B, S, D = 1, 2048, 640
        Df = D // 2 + 1
        return {
            "x": _w((lambda *s: torch.randn(*s, dtype=torch.bfloat16) * 0.05)(B, S, D)),
            "w_r": _w((lambda *s: torch.randn(*s, dtype=torch.bfloat16) * 0.4)(S, Df) * 0.02),
            "w_i": _w((lambda *s: torch.randn(*s, dtype=torch.bfloat16) * 0.4)(S, Df) * 0.02),
        }
    _A_in = _A_setup()

    def _B_setup():
        B, S, D, F = 1, 2048, 640, 1728
        return {
            "x": _w((lambda *s: torch.randn(*s, dtype=torch.bfloat16) * 0.05)(B, S, D)),
            "w_gate": _w((lambda *s: torch.randn(*s, dtype=torch.bfloat16) * 0.05)(D, F)),
            "w_up": _w((lambda *s: torch.randn(*s, dtype=torch.bfloat16) * 0.05)(D, F)),
            "w_down": _w((lambda *s: torch.randn(*s, dtype=torch.bfloat16) * 0.05)(F, D)),
        }
    _B_in = _B_setup()

    return {
        "A_x": _A_in["x"],
        "A_w_r": _A_in["w_r"],
        "A_w_i": _A_in["w_i"],
        "B_x": _B_in["x"],
        "B_w_gate": _B_in["w_gate"],
        "B_w_up": _B_in["w_up"],
        "B_w_down": _B_in["w_down"],
    }

def reference(A_x, A_w_r, A_w_i, B_x, B_w_gate, B_w_up, B_w_down):
    def _A_ref(x, w_r, w_i):
        B, S, D = x.shape
        X = (lambda x, axes=(-2,-1): torch.fft.rfft2(x.float(), dim=axes))(x, axes=(-2, -1))
        W = w_r + 1j * w_i
        X = X * W
        y = (lambda x, s, axes=(-2,-1): torch.fft.irfft2(x, s=s, dim=axes).to(torch.bfloat16))(X, (S, D), axes=(-2, -1))
        return y

    def _B_ref(x, w_gate, w_up, w_down):
        return (_gelu(x @ w_gate) * (x @ w_up)) @ w_down

    x = A_x
    h = x + _A_ref(_layernorm(x, axis=-1), A_w_r, A_w_i)
    h2 = h + _B_ref(_layernorm(h, axis=-1), B_w_gate, B_w_up, B_w_down)
    return h2
```

```asm
; @launch kernel=k1_kernel grid=(256,1,1) block=(512,1,1) lds=58368
; @launch kernel=k2_kernel grid=(321,1,1) block=(256,1,1) lds=17408
; @launch kernel=k3_kernel grid=(256,1,1) block=(512,1,1) lds=25600
; @launch kernel=k4_kernel grid=(256,1,1) block=(640,1,1) lds=147520
; @launch kernel=k5_kernel grid=(256,1,1) block=(384,1,1) lds=147456
.amdgcn_target "amdgcn-amd-amdhsa--gfx950"
.text
.globl k1_kernel
.p2align 8
.type k1_kernel,@function
k1_kernel:
    s_load_dwordx2 s[4:5], s[0:1], 0
    s_load_dwordx4 s[8:11], s[0:1], 8
    s_load_dwordx2 s[6:7], s[0:1], 72
    s_load_dwordx2 s[36:37], s[0:1], 32
    s_cmp_ge_u32 s2, 256
    s_cbranch_scc1 k1_end
    s_setprio 3
    v_lshrrev_b32 v4, 6, v0
    v_and_b32 v1, 31, v0
    v_readfirstlane_b32 s20, v4
    v_bfe_u32 v2, v0, 5, 1
    s_and_b32 s21, s2, 7
    s_lshl_b32 s21, s21, 5
    s_lshr_b32 s22, s2, 3
    s_add_u32 s21, s21, s22
    s_lshr_b32 s22, s21, 3
    s_and_b32 s23, s21, 7
    s_lshl_b32 s23, s23, 3
    s_add_u32 s23, s23, s20
    s_lshl_b32 s23, s23, 5
    s_add_u32 s23, s23, s22
    s_mul_i32 s24, s23, 1280
    v_and_b32 v24, 63, v0
    v_mov_b32 v4, 0x80000000
    v_cmp_gt_u32 vcc, 17, v24
    v_lshlrev_b32 v24, 4, v24
    v_add_u32 v25, 1024, v24
    v_cndmask_b32 v25, v4, v25, vcc
    s_lshr_b32 s32, s21, 6
    s_lshl_b32 s32, s32, 4
    s_and_b32 s33, s21, 7
    s_lshl_b32 s33, s33, 1
    s_add_u32 s32, s32, s33
    s_bfe_u32 s33, s21, 0x30003
    s_lshl_b32 s33, s33, 8
    s_add_u32 s32, s32, s33
    s_and_b32 s33, s20, 3
    s_lshl_b32 s33, s33, 6
    s_add_u32 s32, s32, s33
    s_mul_i32 s32, s32, 642
    s_lshl_b32 s33, s20, 11
    s_waitcnt lgkmcnt(0)
    s_mov_b32 s12, s4
    s_mov_b32 s13, s5
    s_mov_b32 s14, 0x280000
    s_mov_b32 s15, 0x00020000
    s_add_u32 m0, s33, 25600
    s_nop 0
    buffer_load_dwordx4 v24, s[12:15], s24 offen lds
    s_add_u32 m0, s33, 26624
    s_nop 0
    buffer_load_dwordx4 v25, s[12:15], s24 offen lds
    s_cmp_ge_u32 s20, 4
    s_cselect_b32 s8, s10, s8
    s_cselect_b32 s9, s11, s9
    s_mov_b32 s48, s8
    s_mov_b32 s49, s9
    s_mov_b32 s50, 0x141000
    s_mov_b32 s51, 0x00020000
    s_setprio 0
    s_mov_b32 s16, s6
    s_mov_b32 s17, s7
    s_mov_b32 s18, 0x282000
    s_mov_b32 s19, 0x00020000
    s_add_u32 s56, s6, 0x300000
    s_addc_u32 s57, s7, 0
    s_mov_b32 s58, 0x282000
    s_mov_b32 s59, 0x00020000
    v_mov_b32 v8, 0
    v_mov_b32 v9, 0
    v_mov_b32 v10, 0
    v_mov_b32 v11, 0
    v_mov_b32 v12, 0
    v_mov_b32 v13, 0
    v_mov_b32 v14, 0
    v_mov_b32 v15, 0
    v_mov_b32 v16, 0
    v_mov_b32 v17, 0
    v_mov_b32 v18, 0
    v_mov_b32 v19, 0
    v_mov_b32 v20, 0
    v_mov_b32 v21, 0
    v_mov_b32 v22, 0
    v_mov_b32 v23, 0
    v_mul_u32_u24 v3, 160, v2
    v_add_lshl_u32 v3, v3, v1, 1
    v_add_u32 v3, s33, v3
    v_lshlrev_b32 v44, 1, v0
    v_lshlrev_b32 v45, 13, v0
    v_and_b32 v55, 63, v0
    v_cvt_f32_u32 v54, v1
    v_lshlrev_b32 v55, 4, v55
    v_mul_f32 v56, 0x3d000000, v54
    s_add_u32 s40, s20, 0
    s_lshr_b32 s47, s40, 2
    s_lshl_b32 s47, s47, 10
    s_and_b32 s40, s40, 3
    s_lshl_b32 s40, s40, 2
    s_add_u32 s40, s40, s47
    s_lshr_b32 s47, s20, 2
    s_lshl_b32 s47, s47, 3
    s_and_b32 s41, s20, 3
    s_add_u32 s41, s41, s47
    s_lshl_b32 s41, s41, 1
    v_lshl_add_u32 v58, v2, 3, s41
    v_cvt_f32_u32 v58, v58
    v_mul_f32 v58, v58, v56
    v_add_f32 v59, v58, v56
    v_cos_f32 v60, v58
    v_cos_f32 v61, v59
    v_sin_f32 v58, v58
    v_sin_f32 v59, v59
    v_add_u32 v57, s40, v55
    v_cvt_pk_bf16_f32 v60, v60, v61
    v_cvt_pk_bf16_f32 v58, -v58, -v59
    ds_write_b32 v57, v60 offset:12288
    ds_write_b32 v57, v58 offset:14336
    v_mul_f32 v56, 0x3acccccd, v54
    s_lshr_b32 s47, s20, 2
    s_lshl_b32 s47, s47, 3
    s_and_b32 s41, s20, 3
    s_add_u32 s41, s41, s47
    s_add_u32 s40, s20, 28
    s_lshr_b32 s47, s40, 2
    s_lshl_b32 s47, s47, 10
    s_and_b32 s40, s40, 3
    s_lshl_b32 s40, s40, 2
    s_add_u32 s40, s40, s47
    v_lshl_add_u32 v58, v2, 2, s41
    v_cvt_f32_u32 v58, v58
    v_mul_f32 v58, v58, v56
    v_add_u32 v57, s40, v55
    v_cos_f32 v59, v58
    v_sin_f32 v60, v58
    s_nop 0
    ds_write_b32 v57, v59 offset:12288
    ds_write_b32 v57, v60 offset:15360
    s_and_b32 s42, s20, 3
    s_add_u32 s42, s42, 8
    s_lshr_b32 s47, s42, 2
    s_lshl_b32 s47, s47, 3
    s_and_b32 s41, s42, 3
    s_add_u32 s41, s41, s47
    s_add_u32 s40, s42, 28
    s_lshr_b32 s47, s40, 2
    s_lshl_b32 s47, s47, 10
    s_and_b32 s40, s40, 3
    s_lshl_b32 s40, s40, 2
    s_add_u32 s40, s40, s47
    v_lshl_add_u32 v58, v2, 2, s41
    v_cvt_f32_u32 v58, v58
    v_mul_f32 v58, v58, v56
    v_add_u32 v57, s40, v55
    v_cos_f32 v59, v58
    v_sin_f32 v60, v58
    s_nop 0
    ds_write_b32 v57, v59 offset:12288
    ds_write_b32 v57, v60 offset:15360
    s_min_u32 s46, s20, 5
    s_lshl_b32 s42, s46, 1
    s_lshr_b32 s47, s42, 2
    s_lshl_b32 s47, s47, 3
    s_and_b32 s41, s42, 3
    s_add_u32 s41, s41, s47
    s_cmp_ge_u32 s46, 4
    s_cselect_b32 s42, 4, 0
    s_cselect_b32 s43, 6, 4
    s_add_u32 s42, s42, s46
    s_add_u32 s43, s43, s46
    s_cmp_ge_u32 s46, 4
    s_mov_b32 vcc_lo, -1
    s_cselect_b32 vcc_hi, 0, -1
    v_lshrrev_b32 v58, 1, v1
    v_cvt_f32_u32 v58, v58
    v_mul_f32 v56, 0x3d4ccccd, v58
    s_add_u32 s44, s42, 16
    s_lshr_b32 s47, s44, 2
    s_lshl_b32 s47, s47, 10
    s_and_b32 s44, s44, 3
    s_lshl_b32 s44, s44, 2
    s_add_u32 s44, s44, s47
    s_add_u32 s45, s43, 16
    s_lshr_b32 s47, s45, 2
    s_lshl_b32 s47, s47, 10
    s_and_b32 s45, s45, 3
    s_lshl_b32 s45, s45, 2
    s_add_u32 s45, s45, s47
    v_lshl_add_u32 v58, v2, 2, s41
    v_cvt_f32_u32 v58, v58
    v_mul_f32 v58, v58, v56
    v_and_b32 v59, 1, v1
    v_cvt_f32_u32 v59, v59
    v_fmac_f32 v58, 0x3e800000, v59
    v_add_f32 v59, v58, v56
    v_cos_f32 v60, v58
    v_cos_f32 v61, v59
    v_sin_f32 v58, v58
    v_sin_f32 v59, v59
    v_add_u32 v56, s44, v55
    v_add_u32 v57, s45, v55
    v_cvt_pk_bf16_f32 v60, v60, v61
    v_cvt_pk_bf16_f32 v58, v58, v59
    v_mov_b32 v61, 0
    v_cndmask_b32 v60, v61, v60, vcc
    v_cndmask_b32 v58, 0, v58, vcc
    ds_write_b32 v56, v60 offset:12288
    ds_write_b32 v57, v58 offset:12288
    s_add_u32 m0, s33, 41984
    s_nop 0
    buffer_load_dwordx4 v24, s[48:51], s32 offen lds
    s_add_u32 m0, s33, 43008
    s_nop 0
    buffer_load_dwordx4 v25, s[48:51], s32 offen lds
    v_lshlrev_b32 v58, 6, v2
    v_add_lshl_u32 v116, v58, v1, 5
    s_lshl_b32 s26, s20, 2
    v_add_u32 v116, s26, v116
    v_lshlrev_b32 v117, 4, v0
    v_lshrrev_b32 v58, 1, v0
    v_lshlrev_b32 v58, 13, v58
    v_and_b32 v59, 1, v0
    v_lshl_add_u32 v118, v59, 4, v58
    s_lshl_b32 s27, s21, 5
    s_add_u32 s28, s27, 0x200000
    s_waitcnt lgkmcnt(0)
    s_barrier
    ds_read_b128 v[64:67], v55 offset:12288
    ds_read_b128 v[68:71], v55 offset:13312
    ds_read_b128 v[72:75], v55 offset:14336
    ds_read_b128 v[76:79], v55 offset:15360
    ds_read_b128 v[80:83], v55 offset:16384
    ds_read_b128 v[84:87], v55 offset:17408
    ds_read_b128 v[88:91], v55 offset:18432
    ds_read_b128 v[92:95], v55 offset:19456
    ds_read_b128 v[96:99], v55 offset:20480
    ds_read_b128 v[100:103], v55 offset:21504
    ds_read_b128 v[104:107], v55 offset:22528
    ds_read_b128 v[108:111], v55 offset:23552
    ds_read_b128 v[112:115], v55 offset:24576
    s_waitcnt vmcnt(2)
    s_mov_b32 exec_lo, 0xfffff
    s_mov_b32 exec_hi, 0xfffff
    ds_read_u16_d16_hi v8, v3 offset:25600
    ds_read_u16_d16_hi v9, v3 offset:25640
    ds_read_u16_d16_hi v10, v3 offset:25680
    ds_read_u16_d16_hi v11, v3 offset:25720
    ds_read_u16_d16_hi v12, v3 offset:25760
    ds_read_u16_d16_hi v13, v3 offset:25800
    ds_read_u16_d16_hi v14, v3 offset:25840
    ds_read_u16_d16_hi v15, v3 offset:25880
    ds_read_u16_d16_hi v16, v3 offset:26240
    ds_read_u16_d16_hi v17, v3 offset:26280
    ds_read_u16_d16_hi v18, v3 offset:26320
    ds_read_u16_d16_hi v19, v3 offset:26360
    ds_read_u16_d16_hi v20, v3 offset:26400
    ds_read_u16_d16_hi v21, v3 offset:26440
    ds_read_u16_d16_hi v22, v3 offset:26480
    ds_read_u16_d16_hi v23, v3 offset:26520
    s_mov_b64 exec, -1
    s_waitcnt lgkmcnt(0)
    v_pk_add_f32 v[46:47], v[8:9], v[10:11]
    v_pk_mul_f32 v[48:49], v[8:9], v[8:9]
    v_pk_add_f32 v[50:51], v[12:13], v[14:15]
    v_pk_mul_f32 v[52:53], v[12:13], v[12:13]
    v_pk_fma_f32 v[48:49], v[10:11], v[10:11], v[48:49]
    v_pk_fma_f32 v[52:53], v[14:15], v[14:15], v[52:53]
    v_pk_add_f32 v[46:47], v[46:47], v[16:17]
    v_pk_fma_f32 v[48:49], v[16:17], v[16:17], v[48:49]
    v_pk_add_f32 v[50:51], v[50:51], v[18:19]
    v_pk_fma_f32 v[52:53], v[18:19], v[18:19], v[52:53]
    v_pk_add_f32 v[46:47], v[46:47], v[20:21]
    v_pk_fma_f32 v[48:49], v[20:21], v[20:21], v[48:49]
    v_pk_add_f32 v[50:51], v[50:51], v[22:23]
    v_pk_fma_f32 v[52:53], v[22:23], v[22:23], v[52:53]
    v_pk_add_f32 v[46:47], v[46:47], v[50:51]
    v_pk_add_f32 v[48:49], v[48:49], v[52:53]
    v_add_f32 v56, v46, v47
    v_add_f32 v57, v48, v49
    s_nop 1
    v_permlane32_swap_b32 v56, v57
    v_add_f32 v56, v56, v57
    v_mov_b32 v57, v56
    s_nop 1
    v_permlane16_swap_b32 v56, v57
    v_add_f32 v56, v56, v57
    s_nop 1
    v_add_f32_dpp v56, v56, v56 quad_perm:[1,0,3,2] row_mask:0xf bank_mask:0xf
    s_nop 1
    v_add_f32_dpp v56, v56, v56 quad_perm:[2,3,0,1] row_mask:0xf bank_mask:0xf
    s_nop 1
    v_add_f32_dpp v56, v56, v56 row_half_mirror row_mask:0xf bank_mask:0xf
    s_nop 1
    v_add_f32_dpp v56, v56, v56 row_mirror row_mask:0xf bank_mask:0xf
    s_nop 0
    v_readlane_b32 s30, v56, 0
    v_readlane_b32 s31, v56, 32
    s_nop 0
    v_mov_b32 v58, s30
    v_mov_b32 v59, s31
    v_mul_f32 v58, 0x3acccccd, v58
    v_mul_f32 v59, 0x3acccccd, v59
    v_fma_f32 v59, -v58, v58, v59
    v_cvt_pk_bf16_f32 v58, v58, v59
    v_lshlrev_b32 v54, 16, v58
    v_and_b32 v59, 0xffff0000, v58
    v_add_f32 v59, 0x3727c5ac, v59
    v_cvt_pk_bf16_f32 v59, v59, v59
    v_and_b32 v59, 0xffff0000, v59
    v_sqrt_f32 v58, v59
    s_nop 0
    v_cvt_pk_bf16_f32 v58, v58, v58
    v_and_b32 v58, 0xffff0000, v58
    v_rcp_f32 v55, v58
    s_nop 0
    v_fma_f32 v59, -v58, v55, 2.0
    v_mul_f32 v55, v55, v59
    v_pk_add_f32 v[8:9], v[8:9], v[54:55] op_sel_hi:[1,0] neg_lo:[0,1] neg_hi:[0,1]
    v_pk_add_f32 v[10:11], v[10:11], v[54:55] op_sel_hi:[1,0] neg_lo:[0,1] neg_hi:[0,1]
    v_pk_add_f32 v[12:13], v[12:13], v[54:55] op_sel_hi:[1,0] neg_lo:[0,1] neg_hi:[0,1]
    v_pk_add_f32 v[14:15], v[14:15], v[54:55] op_sel_hi:[1,0] neg_lo:[0,1] neg_hi:[0,1]
    v_cvt_pk_bf16_f32 v8, 0, v8
    v_cvt_pk_bf16_f32 v10, 0, v10
    v_cvt_pk_bf16_f32 v12, 0, v12
    v_cvt_pk_bf16_f32 v14, 0, v14
    v_cvt_pk_bf16_f32 v9, 0, v9
    v_cvt_pk_bf16_f32 v11, 0, v11
    v_cvt_pk_bf16_f32 v13, 0, v13
    v_cvt_pk_bf16_f32 v15, 0, v15
    v_pk_mul_f32 v[8:9], v[8:9], v[54:55] op_sel:[0,1] op_sel_hi:[1,1]
    v_pk_mul_f32 v[10:11], v[10:11], v[54:55] op_sel:[0,1] op_sel_hi:[1,1]
    v_pk_mul_f32 v[12:13], v[12:13], v[54:55] op_sel:[0,1] op_sel_hi:[1,1]
    v_pk_mul_f32 v[14:15], v[14:15], v[54:55] op_sel:[0,1] op_sel_hi:[1,1]
    v_cvt_pk_bf16_f32 v120, v8, v9
    v_cvt_pk_bf16_f32 v121, v10, v11
    v_cvt_pk_bf16_f32 v122, v12, v13
    v_cvt_pk_bf16_f32 v123, v14, v15
    s_nop 1
    v_mfma_f32_32x32x16_bf16 v[128:143], v[120:123], v[64:67], 0
    v_mfma_f32_32x32x16_bf16 v[144:159], v[120:123], v[72:75], 0
    v_pk_add_f32 v[16:17], v[16:17], v[54:55] op_sel_hi:[1,0] neg_lo:[0,1] neg_hi:[0,1]
    v_pk_add_f32 v[18:19], v[18:19], v[54:55] op_sel_hi:[1,0] neg_lo:[0,1] neg_hi:[0,1]
    v_pk_add_f32 v[20:21], v[20:21], v[54:55] op_sel_hi:[1,0] neg_lo:[0,1] neg_hi:[0,1]
    v_pk_add_f32 v[22:23], v[22:23], v[54:55] op_sel_hi:[1,0] neg_lo:[0,1] neg_hi:[0,1]
    v_cvt_pk_bf16_f32 v16, 0, v16
    v_cvt_pk_bf16_f32 v18, 0, v18
    v_cvt_pk_bf16_f32 v20, 0, v20
    v_cvt_pk_bf16_f32 v22, 0, v22
    v_cvt_pk_bf16_f32 v17, 0, v17
    v_cvt_pk_bf16_f32 v19, 0, v19
    v_cvt_pk_bf16_f32 v21, 0, v21
    v_cvt_pk_bf16_f32 v23, 0, v23
    v_pk_mul_f32 v[16:17], v[16:17], v[54:55] op_sel:[0,1] op_sel_hi:[1,1]
    v_pk_mul_f32 v[18:19], v[18:19], v[54:55] op_sel:[0,1] op_sel_hi:[1,1]
    v_pk_mul_f32 v[20:21], v[20:21], v[54:55] op_sel:[0,1] op_sel_hi:[1,1]
    v_pk_mul_f32 v[22:23], v[22:23], v[54:55] op_sel:[0,1] op_sel_hi:[1,1]
    v_cvt_pk_bf16_f32 v124, v16, v17
    v_cvt_pk_bf16_f32 v125, v18, v19
    v_cvt_pk_bf16_f32 v126, v20, v21
    v_cvt_pk_bf16_f32 v127, v22, v23
    s_nop 1
    v_mfma_f32_32x32x16_bf16 v[128:143], v[124:127], v[68:71], v[128:143]
    v_mfma_f32_32x32x16_bf16 v[144:159], v[124:127], v[76:79], v[144:159]
    s_nop 10
    v_pk_mul_f32 v[46:47], v[128:129], v[92:93]
    v_pk_mul_f32 v[50:51], v[130:131], v[94:95]
    v_pk_mul_f32 v[48:49], v[144:145], v[92:93]
    v_pk_mul_f32 v[52:53], v[146:147], v[94:95]
    v_pk_fma_f32 v[46:47], v[144:145], v[104:105], v[46:47]
    v_pk_fma_f32 v[50:51], v[146:147], v[106:107], v[50:51]
    v_pk_fma_f32 v[48:49], v[128:129], v[104:105], v[48:49] neg_lo:[1,0,0] neg_hi:[1,0,0]
    v_pk_fma_f32 v[52:53], v[130:131], v[106:107], v[52:53] neg_lo:[1,0,0] neg_hi:[1,0,0]
    v_cvt_pk_bf16_f32 v8, v46, v47
    v_cvt_pk_bf16_f32 v9, v50, v51
    v_cvt_pk_bf16_f32 v12, v48, v49
    v_cvt_pk_bf16_f32 v13, v52, v53
    v_pk_mul_f32 v[46:47], v[132:133], v[96:97]
    v_pk_mul_f32 v[50:51], v[134:135], v[98:99]
    v_pk_mul_f32 v[48:49], v[148:149], v[96:97]
    v_pk_mul_f32 v[52:53], v[150:151], v[98:99]
    v_pk_fma_f32 v[46:47], v[148:149], v[108:109], v[46:47]
    v_pk_fma_f32 v[50:51], v[150:151], v[110:111], v[50:51]
    v_pk_fma_f32 v[48:49], v[132:133], v[108:109], v[48:49] neg_lo:[1,0,0] neg_hi:[1,0,0]
    v_pk_fma_f32 v[52:53], v[134:135], v[110:111], v[52:53] neg_lo:[1,0,0] neg_hi:[1,0,0]
    v_cvt_pk_bf16_f32 v10, v46, v47
    v_cvt_pk_bf16_f32 v11, v50, v51
    v_cvt_pk_bf16_f32 v14, v48, v49
    v_cvt_pk_bf16_f32 v15, v52, v53
    v_mfma_f32_32x32x16_bf16 v[64:79], v[80:83], v[8:11], 0
    s_nop 0
    v_mfma_f32_32x32x16_bf16 v[64:79], v[84:87], v[12:15], v[64:79]
    v_pk_mul_f32 v[46:47], v[136:137], v[100:101]
    v_pk_mul_f32 v[50:51], v[138:139], v[102:103]
    v_pk_mul_f32 v[48:49], v[152:153], v[100:101]
    v_pk_mul_f32 v[52:53], v[154:155], v[102:103]
    v_pk_fma_f32 v[46:47], v[152:153], v[112:113], v[46:47]
    v_pk_fma_f32 v[50:51], v[154:155], v[114:115], v[50:51]
    v_pk_fma_f32 v[48:49], v[136:137], v[112:113], v[48:49] neg_lo:[1,0,0] neg_hi:[1,0,0]
    v_pk_fma_f32 v[52:53], v[138:139], v[114:115], v[52:53] neg_lo:[1,0,0] neg_hi:[1,0,0]
    v_cvt_pk_bf16_f32 v16, v46, v47
    v_cvt_pk_bf16_f32 v17, v50, v51
    v_cvt_pk_bf16_f32 v18, v48, v49
    v_cvt_pk_bf16_f32 v19, v52, v53
    s_nop 1
    v_mfma_f32_32x32x16_bf16 v[64:79], v[88:91], v[16:19], v[64:79]
    s_waitcnt vmcnt(0)
    s_barrier
    ds_read_u16 v28, v44 offset:41984
    ds_read_u16 v36, v44 offset:50176
    ds_read_u16 v29, v44 offset:44032
    ds_read_u16 v37, v44 offset:52224
    ds_read_u16 v30, v44 offset:46080
    ds_read_u16 v38, v44 offset:54272
    ds_read_u16 v31, v44 offset:48128
    ds_read_u16 v39, v44 offset:56320
    ds_read_u16 v32, v44 offset:42626
    ds_read_u16 v40, v44 offset:50818
    ds_read_u16 v33, v44 offset:44674
    ds_read_u16 v41, v44 offset:52866
    ds_read_u16 v34, v44 offset:46722
    ds_read_u16 v42, v44 offset:54914
    ds_read_u16 v35, v44 offset:48770
    ds_read_u16 v43, v44 offset:56962
    v_cvt_pk_bf16_f32 v120, v64, v65
    ds_write_b32 v116, v120 offset:0
    v_cvt_pk_bf16_f32 v121, v66, v67
    ds_write_b32 v116, v121 offset:1024
    v_cvt_pk_bf16_f32 v122, v68, v69
    ds_write_b32 v116, v122 offset:4096
    v_cvt_pk_bf16_f32 v123, v70, v71
    ds_write_b32 v116, v123 offset:5120
    v_cvt_pk_bf16_f32 v124, v72, v73
    ds_write_b32 v116, v124 offset:8192
    v_cvt_pk_bf16_f32 v125, v74, v75
    ds_write_b32 v116, v125 offset:9216
    s_waitcnt lgkmcnt(14)
    v_lshl_or_b32 v28, v36, 16, v28
    v_lshl_or_b32 v29, v37, 16, v29
    v_lshl_or_b32 v30, v38, 16, v30
    v_lshl_or_b32 v31, v39, 16, v31
    buffer_store_dwordx4 v[28:31], v45, s[56:59], s27 offen offset:0
    s_waitcnt lgkmcnt(6)
    v_lshl_or_b32 v32, v40, 16, v32
    v_lshl_or_b32 v33, v41, 16, v33
    v_lshl_or_b32 v34, v42, 16, v34
    v_lshl_or_b32 v35, v43, 16, v35
    buffer_store_dwordx4 v[32:35], v45, s[56:59], s27 offen offset:16
    s_waitcnt lgkmcnt(0)
    s_barrier
    ds_read_b128 v[128:131], v117
    s_cmp_ge_u32 s20, 3
    s_cbranch_scc1 k1_one
    ds_read_b128 v[132:135], v117 offset:8192
k1_one:
    s_waitcnt lgkmcnt(0)
    buffer_store_dwordx4 v[128:131], v118, s[16:19], s27 offen
    s_cbranch_scc1 k1_two
    buffer_store_dwordx4 v[132:135], v118, s[16:19], s28 offen
k1_two:
k1_end:
    s_endpgm
.globl k2_kernel
.p2align 8
.type k2_kernel,@function
k2_kernel:
    s_load_dwordx2 s[6:7], s[0:1], 72
    s_load_dwordx4 s[8:11], s[0:1], 32
    s_load_dwordx2 s[4:5], s[0:1], 48
    s_cmp_ge_u32 s2, 321
    s_cbranch_scc1 k2_end
    v_and_b32 v1, 15, v0
    v_bfe_u32 v2, v0, 4, 2
    v_lshrrev_b32 v3, 6, v0
    s_setprio 3
    v_readfirstlane_b32 s23, v3
    v_lshl_add_u32 v6, v3, 3, v2
    v_and_b32 v4, 15, v6
    v_xor_b32 v4, v4, v1
    v_lshlrev_b32 v4, 4, v4
    v_lshl_add_u32 v48, v6, 8, v4
    v_lshl_add_u32 v6, v3, 3, v2
    v_add_u32 v6, 4, v6
    v_and_b32 v4, 15, v6
    v_xor_b32 v4, v4, v1
    v_lshlrev_b32 v4, 4, v4
    v_lshl_add_u32 v49, v6, 8, v4
    s_lshl_b32 s23, s23, 11
    v_lshlrev_b32 v6, 4, v1
    v_lshl_add_u32 v6, v2, 8, v6
    v_lshl_add_u32 v5, v3, 11, v6
    s_lshl_b32 s20, s2, 13
    s_add_u32 s21, s20, 4096
    s_waitcnt lgkmcnt(0)
    s_mov_b32 s12, s6
    s_mov_b32 s13, s7
    s_mov_b32 s14, 0x282000
    s_mov_b32 s15, 0x00020000
    s_add_u32 s16, s6, 0x300000
    s_addc_u32 s17, s7, 0
    s_mov_b32 s18, 0x282000
    s_mov_b32 s19, 0x00020000
    s_add_u32 s24, s6, 0x600000
    s_addc_u32 s25, s7, 0
    s_mov_b32 s26, 0x282000
    s_mov_b32 s27, 0x00020000
    s_add_u32 m0, s23, 9216
    s_nop 0
    buffer_load_dwordx4 v48, s[12:15], s20 offen lds
    s_add_u32 m0, s23, 10240
    s_nop 0
    buffer_load_dwordx4 v49, s[12:15], s20 offen lds
    buffer_load_dwordx4 v[40:43], v5, s[16:19], s20 offen offset:0
    buffer_load_dwordx4 v[44:47], v5, s[16:19], s20 offen offset:1024
    s_setprio 0
    v_xor_b32 v6, v2, v1
    v_lshlrev_b32 v6, 4, v6
    v_lshl_add_u32 v50, v1, 8, v6
    v_xor_b32 v51, 64, v50
    v_xor_b32 v52, 128, v50
    v_xor_b32 v53, 192, v50
    s_mov_b32 s22, 0x35cccccd
    s_cmp_eq_u32 s2, 0
    s_cselect_b32 s22, 0x354ccccd, s22
    s_cmp_eq_u32 s2, 320
    s_cselect_b32 s22, 0x354ccccd, s22
    v_lshl_add_u32 v6, v3, 4, v1
    v_and_b32 v59, 63, v0
    v_cvt_f32_u32 v60, v59
    v_mul_f32 v60, 0x3c800000, v60
    v_cos_f32 v61, v60
    v_sin_f32 v62, v60
    v_lshlrev_b32 v59, 2, v59
    v_cvt_pk_bf16_f32 v61, v61, v62
    ds_write2st64_b32 v59, v61, v61 offset0:34 offset1:35
    v_lshlrev_b32 v57, 2, v6
    v_lshlrev_b32 v55, 2, v2
    v_mul_u32_u24 v58, v57, v55
    v_and_b32 v59, 0xfc, v58
    ds_read_b32 v64, v59 offset:8704
    ds_read_b32 v80, v59 offset:8768
    v_mad_u32_u24 v60, v57, 1, v58
    v_and_b32 v60, 0xfc, v60
    ds_read_b32 v65, v60 offset:8704
    ds_read_b32 v81, v60 offset:8768
    v_mad_u32_u24 v61, v57, 2, v58
    v_and_b32 v61, 0xfc, v61
    ds_read_b32 v66, v61 offset:8704
    ds_read_b32 v82, v61 offset:8768
    v_mad_u32_u24 v62, v57, 3, v58
    v_and_b32 v62, 0xfc, v62
    ds_read_b32 v67, v62 offset:8704
    ds_read_b32 v83, v62 offset:8768
    v_mad_u32_u24 v59, v57, 16, v58
    v_and_b32 v59, 0xfc, v59
    ds_read_b32 v68, v59 offset:8704
    ds_read_b32 v84, v59 offset:8768
    v_mad_u32_u24 v60, v57, 17, v58
    v_and_b32 v60, 0xfc, v60
    ds_read_b32 v69, v60 offset:8704
    ds_read_b32 v85, v60 offset:8768
    v_mad_u32_u24 v61, v57, 18, v58
    v_and_b32 v61, 0xfc, v61
    ds_read_b32 v70, v61 offset:8704
    ds_read_b32 v86, v61 offset:8768
    v_mad_u32_u24 v62, v57, 19, v58
    v_and_b32 v62, 0xfc, v62
    ds_read_b32 v71, v62 offset:8704
    ds_read_b32 v87, v62 offset:8768
    v_mad_u32_u24 v59, v57, 32, v58
    v_and_b32 v59, 0xfc, v59
    ds_read_b32 v72, v59 offset:8704
    ds_read_b32 v88, v59 offset:8768
    v_mad_u32_u24 v60, v57, 33, v58
    v_and_b32 v60, 0xfc, v60
    ds_read_b32 v73, v60 offset:8704
    ds_read_b32 v89, v60 offset:8768
    v_mad_u32_u24 v61, v57, 34, v58
    v_and_b32 v61, 0xfc, v61
    ds_read_b32 v74, v61 offset:8704
    ds_read_b32 v90, v61 offset:8768
    v_mad_u32_u24 v62, v57, 35, v58
    v_and_b32 v62, 0xfc, v62
    ds_read_b32 v75, v62 offset:8704
    ds_read_b32 v91, v62 offset:8768
    v_mad_u32_u24 v59, v57, 48, v58
    v_and_b32 v59, 0xfc, v59
    ds_read_b32 v76, v59 offset:8704
    ds_read_b32 v92, v59 offset:8768
    v_mad_u32_u24 v60, v57, 49, v58
    v_and_b32 v60, 0xfc, v60
    ds_read_b32 v77, v60 offset:8704
    ds_read_b32 v93, v60 offset:8768
    v_mad_u32_u24 v61, v57, 50, v58
    v_and_b32 v61, 0xfc, v61
    ds_read_b32 v78, v61 offset:8704
    ds_read_b32 v94, v61 offset:8768
    v_mad_u32_u24 v62, v57, 51, v58
    v_and_b32 v62, 0xfc, v62
    ds_read_b32 v79, v62 offset:8704
    ds_read_b32 v95, v62 offset:8768
    v_lshlrev_b32 v57, 3, v1
    v_mul_u32_u24 v58, v57, v55
    v_and_b32 v59, 0xfc, v58
    ds_read_b32 v104, v59 offset:8704
    v_mad_u32_u24 v60, v57, 1, v58
    v_and_b32 v60, 0xfc, v60
    ds_read_b32 v112, v60 offset:8704
    v_mad_u32_u24 v61, v57, 2, v58
    v_and_b32 v61, 0xfc, v61
    ds_read_b32 v105, v61 offset:8704
    v_mad_u32_u24 v62, v57, 3, v58
    v_and_b32 v62, 0xfc, v62
    ds_read_b32 v113, v62 offset:8704
    v_mad_u32_u24 v59, v57, 16, v58
    v_and_b32 v59, 0xfc, v59
    ds_read_b32 v106, v59 offset:8704
    v_mad_u32_u24 v60, v57, 17, v58
    v_and_b32 v60, 0xfc, v60
    ds_read_b32 v114, v60 offset:8704
    v_mad_u32_u24 v61, v57, 18, v58
    v_and_b32 v61, 0xfc, v61
    ds_read_b32 v107, v61 offset:8704
    v_mad_u32_u24 v62, v57, 19, v58
    v_and_b32 v62, 0xfc, v62
    ds_read_b32 v115, v62 offset:8704
    v_add_u32 v57, 128, v57
    v_mul_u32_u24 v58, v57, v55
    v_and_b32 v59, 0xfc, v58
    ds_read_b32 v108, v59 offset:8704
    v_mad_u32_u24 v60, v57, 1, v58
    v_and_b32 v60, 0xfc, v60
    ds_read_b32 v116, v60 offset:8704
    v_mad_u32_u24 v61, v57, 2, v58
    v_and_b32 v61, 0xfc, v61
    ds_read_b32 v109, v61 offset:8704
    v_mad_u32_u24 v62, v57, 3, v58
    v_and_b32 v62, 0xfc, v62
    ds_read_b32 v117, v62 offset:8704
    v_mad_u32_u24 v59, v57, 16, v58
    v_and_b32 v59, 0xfc, v59
    ds_read_b32 v110, v59 offset:8704
    v_mad_u32_u24 v60, v57, 17, v58
    v_and_b32 v60, 0xfc, v60
    ds_read_b32 v118, v60 offset:8704
    v_mad_u32_u24 v61, v57, 18, v58
    v_and_b32 v61, 0xfc, v61
    ds_read_b32 v111, v61 offset:8704
    v_mad_u32_u24 v62, v57, 19, v58
    v_and_b32 v62, 0xfc, v62
    ds_read_b32 v119, v62 offset:8704
    v_cvt_f32_u32 v54, v6
    v_cvt_f32_u32 v55, v55
    v_mul_f32 v57, 0x3a000000, v54
    v_mul_f32 v58, v57, v55
    v_mov_b32 v59, v58
    v_cos_f32 v120, v59
    v_sin_f32 v128, v59
    v_fmamk_f32 v59, v57, 0x3f800000, v58
    v_cos_f32 v121, v59
    v_sin_f32 v129, v59
    v_fmamk_f32 v59, v57, 0x40000000, v58
    v_cos_f32 v122, v59
    v_sin_f32 v130, v59
    v_fmamk_f32 v59, v57, 0x40400000, v58
    v_cos_f32 v123, v59
    v_sin_f32 v131, v59
    v_fmamk_f32 v59, v57, 0x41800000, v58
    v_cos_f32 v124, v59
    v_sin_f32 v132, v59
    v_fmamk_f32 v59, v57, 0x41880000, v58
    v_cos_f32 v125, v59
    v_sin_f32 v133, v59
    v_fmamk_f32 v59, v57, 0x41900000, v58
    v_cos_f32 v126, v59
    v_sin_f32 v134, v59
    v_fmamk_f32 v59, v57, 0x41980000, v58
    v_cos_f32 v127, v59
    v_sin_f32 v135, v59
    s_mov_b32 s36, 0x05040100
    s_mov_b32 s37, 0x07060302
    s_mov_b32 s38, 0x80008000
    s_waitcnt lgkmcnt(0)
    v_perm_b32 v96, v112, v104, s36
    v_perm_b32 v104, v112, v104, s37
    v_xor_b32 v112, s38, v104
    v_perm_b32 v97, v113, v105, s36
    v_perm_b32 v105, v113, v105, s37
    v_xor_b32 v113, s38, v105
    v_perm_b32 v98, v114, v106, s36
    v_perm_b32 v106, v114, v106, s37
    v_xor_b32 v114, s38, v106
    v_perm_b32 v99, v115, v107, s36
    v_perm_b32 v107, v115, v107, s37
    v_xor_b32 v115, s38, v107
    v_perm_b32 v100, v116, v108, s36
    v_perm_b32 v108, v116, v108, s37
    v_xor_b32 v116, s38, v108
    v_perm_b32 v101, v117, v109, s36
    v_perm_b32 v109, v117, v109, s37
    v_xor_b32 v117, s38, v109
    v_perm_b32 v102, v118, v110, s36
    v_perm_b32 v110, v118, v110, s37
    v_xor_b32 v118, s38, v110
    v_perm_b32 v103, v119, v111, s36
    v_perm_b32 v111, v119, v111, s37
    v_xor_b32 v119, s38, v111
    v_mul_u32_u24 v59, 1088, v2
    v_lshl_add_u32 v136, v6, 2, v59
    v_mul_u32_u24 v59, 272, v1
    v_lshl_add_u32 v137, v2, 4, v59
    v_lshlrev_b32 v138, 5, v0
    s_waitcnt vmcnt(2)
    s_barrier
    ds_read_b128 v[8:11], v50 offset:9216
    ds_read_b128 v[12:15], v51 offset:9216
    ds_read_b128 v[16:19], v52 offset:9216
    ds_read_b128 v[20:23], v53 offset:9216
    ds_read_b128 v[24:27], v50 offset:13312
    ds_read_b128 v[28:31], v51 offset:13312
    ds_read_b128 v[32:35], v52 offset:13312
    ds_read_b128 v[36:39], v53 offset:13312
    s_waitcnt lgkmcnt(7)
    v_mfma_f32_16x16x32_bf16 v[140:143], v[8:11], v[64:67], 0
    v_mfma_f32_16x16x32_bf16 v[148:151], v[8:11], v[80:83], 0
    s_waitcnt lgkmcnt(6)
    v_mfma_f32_16x16x32_bf16 v[140:143], v[12:15], v[68:71], v[140:143]
    v_mfma_f32_16x16x32_bf16 v[148:151], v[12:15], v[84:87], v[148:151]
    s_waitcnt lgkmcnt(5)
    v_mfma_f32_16x16x32_bf16 v[140:143], v[16:19], v[72:75], v[140:143]
    v_mfma_f32_16x16x32_bf16 v[148:151], v[16:19], v[88:91], v[148:151]
    s_waitcnt lgkmcnt(4)
    v_mfma_f32_16x16x32_bf16 v[140:143], v[20:23], v[76:79], v[140:143]
    v_mfma_f32_16x16x32_bf16 v[148:151], v[20:23], v[92:95], v[148:151]
    s_waitcnt lgkmcnt(3)
    v_mfma_f32_16x16x32_bf16 v[144:147], v[24:27], v[64:67], 0
    v_mfma_f32_16x16x32_bf16 v[152:155], v[24:27], v[80:83], 0
    s_waitcnt lgkmcnt(2)
    v_mfma_f32_16x16x32_bf16 v[144:147], v[28:31], v[68:71], v[144:147]
    v_mfma_f32_16x16x32_bf16 v[152:155], v[28:31], v[84:87], v[152:155]
    s_waitcnt lgkmcnt(1)
    v_mfma_f32_16x16x32_bf16 v[144:147], v[32:35], v[72:75], v[144:147]
    v_mfma_f32_16x16x32_bf16 v[152:155], v[32:35], v[88:91], v[152:155]
    s_waitcnt lgkmcnt(0)
    v_mfma_f32_16x16x32_bf16 v[144:147], v[36:39], v[76:79], v[144:147]
    v_mfma_f32_16x16x32_bf16 v[152:155], v[36:39], v[92:95], v[152:155]
    v_pk_mul_f32 v[180:181], v[140:141], v[120:121]
    v_pk_mul_f32 v[184:185], v[142:143], v[122:123]
    v_pk_mul_f32 v[182:183], v[148:149], v[120:121]
    v_pk_mul_f32 v[186:187], v[150:151], v[122:123]
    v_pk_fma_f32 v[180:181], v[148:149], v[128:129], v[180:181]
    v_pk_fma_f32 v[184:185], v[150:151], v[130:131], v[184:185]
    v_pk_fma_f32 v[182:183], v[140:141], v[128:129], v[182:183] neg_lo:[1,0,0] neg_hi:[1,0,0]
    v_pk_fma_f32 v[186:187], v[142:143], v[130:131], v[186:187] neg_lo:[1,0,0] neg_hi:[1,0,0]
    v_cvt_pk_bf16_f32 v172, v180, v181
    v_cvt_pk_bf16_f32 v173, v184, v185
    v_cvt_pk_bf16_f32 v176, v182, v183
    v_cvt_pk_bf16_f32 v177, v186, v187
    v_pk_mul_f32 v[180:181], v[144:145], v[124:125]
    v_pk_mul_f32 v[184:185], v[146:147], v[126:127]
    v_pk_mul_f32 v[182:183], v[152:153], v[124:125]
    v_pk_mul_f32 v[186:187], v[154:155], v[126:127]
    v_pk_fma_f32 v[180:181], v[152:153], v[132:133], v[180:181]
    v_pk_fma_f32 v[184:185], v[154:155], v[134:135], v[184:185]
    v_pk_fma_f32 v[182:183], v[144:145], v[132:133], v[182:183] neg_lo:[1,0,0] neg_hi:[1,0,0]
    v_pk_fma_f32 v[186:187], v[146:147], v[134:135], v[186:187] neg_lo:[1,0,0] neg_hi:[1,0,0]
    v_cvt_pk_bf16_f32 v174, v180, v181
    v_cvt_pk_bf16_f32 v175, v184, v185
    v_cvt_pk_bf16_f32 v178, v182, v183
    v_cvt_pk_bf16_f32 v179, v186, v187
    v_mfma_f32_16x16x32_bf16 v[156:159], v[96:99], v[172:175], 0
    s_nop 0
    v_mfma_f32_16x16x32_bf16 v[164:167], v[96:99], v[176:179], 0
    v_mfma_f32_16x16x32_bf16 v[160:163], v[100:103], v[172:175], 0
    v_mfma_f32_16x16x32_bf16 v[168:171], v[100:103], v[176:179], 0
    v_mfma_f32_16x16x32_bf16 v[156:159], v[104:107], v[176:179], v[156:159]
    v_mfma_f32_16x16x32_bf16 v[164:167], v[112:115], v[172:175], v[164:167]
    v_mfma_f32_16x16x32_bf16 v[160:163], v[108:111], v[176:179], v[160:163]
    v_mfma_f32_16x16x32_bf16 v[168:171], v[116:119], v[172:175], v[168:171]
    s_waitcnt vmcnt(0)
    v_mov_b32 v188, s22
    v_mov_b32 v189, s22
    v_lshlrev_b32 v8, 16, v40
    v_and_b32 v16, 0xffff0000, v40
    v_lshlrev_b32 v9, 16, v41
    v_and_b32 v17, 0xffff0000, v41
    v_lshlrev_b32 v10, 16, v42
    v_and_b32 v18, 0xffff0000, v42
    v_lshlrev_b32 v11, 16, v43
    v_and_b32 v19, 0xffff0000, v43
    v_lshlrev_b32 v12, 16, v44
    v_and_b32 v20, 0xffff0000, v44
    v_lshlrev_b32 v13, 16, v45
    v_and_b32 v21, 0xffff0000, v45
    v_lshlrev_b32 v14, 16, v46
    v_and_b32 v22, 0xffff0000, v46
    v_lshlrev_b32 v15, 16, v47
    v_and_b32 v23, 0xffff0000, v47
    v_pk_mul_f32 v[8:9], v[8:9], v[188:189]
    v_pk_mul_f32 v[10:11], v[10:11], v[188:189]
    v_pk_mul_f32 v[12:13], v[12:13], v[188:189]
    v_pk_mul_f32 v[14:15], v[14:15], v[188:189]
    v_pk_mul_f32 v[16:17], v[16:17], v[188:189]
    v_pk_mul_f32 v[18:19], v[18:19], v[188:189]
    v_pk_mul_f32 v[20:21], v[20:21], v[188:189]
    v_pk_mul_f32 v[22:23], v[22:23], v[188:189]
    v_pk_mul_f32 v[180:181], v[156:157], v[8:9]
    v_pk_mul_f32 v[184:185], v[158:159], v[10:11]
    v_pk_mul_f32 v[182:183], v[164:165], v[8:9]
    v_pk_mul_f32 v[186:187], v[166:167], v[10:11]
    v_pk_fma_f32 v[180:181], v[164:165], v[16:17], v[180:181] neg_lo:[1,0,0] neg_hi:[1,0,0]
    v_pk_fma_f32 v[184:185], v[166:167], v[18:19], v[184:185] neg_lo:[1,0,0] neg_hi:[1,0,0]
    v_pk_fma_f32 v[182:183], v[156:157], v[16:17], v[182:183]
    v_pk_fma_f32 v[186:187], v[158:159], v[18:19], v[186:187]
    v_cvt_pk_bf16_f32 v192, v180, v181
    v_cvt_pk_bf16_f32 v193, v184, v185
    v_cvt_pk_bf16_f32 v196, -v182, -v183
    v_cvt_pk_bf16_f32 v197, -v186, -v187
    v_pk_mul_f32 v[180:181], v[160:161], v[12:13]
    v_pk_mul_f32 v[184:185], v[162:163], v[14:15]
    v_pk_mul_f32 v[182:183], v[168:169], v[12:13]
    v_pk_mul_f32 v[186:187], v[170:171], v[14:15]
    v_pk_fma_f32 v[180:181], v[168:169], v[20:21], v[180:181] neg_lo:[1,0,0] neg_hi:[1,0,0]
    v_pk_fma_f32 v[184:185], v[170:171], v[22:23], v[184:185] neg_lo:[1,0,0] neg_hi:[1,0,0]
    v_pk_fma_f32 v[182:183], v[160:161], v[20:21], v[182:183]
    v_pk_fma_f32 v[186:187], v[162:163], v[22:23], v[186:187]
    v_cvt_pk_bf16_f32 v194, v180, v181
    v_cvt_pk_bf16_f32 v195, v184, v185
    v_cvt_pk_bf16_f32 v198, -v182, -v183
    v_cvt_pk_bf16_f32 v199, -v186, -v187
    v_mfma_f32_16x16x32_bf16 v[140:143], v[96:99], v[192:195], 0
    s_nop 0
    v_mfma_f32_16x16x32_bf16 v[148:151], v[96:99], v[196:199], 0
    v_mfma_f32_16x16x32_bf16 v[144:147], v[100:103], v[192:195], 0
    v_mfma_f32_16x16x32_bf16 v[152:155], v[100:103], v[196:199], 0
    v_mfma_f32_16x16x32_bf16 v[140:143], v[104:107], v[196:199], v[140:143]
    v_mfma_f32_16x16x32_bf16 v[148:151], v[112:115], v[192:195], v[148:151]
    v_mfma_f32_16x16x32_bf16 v[144:147], v[108:111], v[196:199], v[144:147]
    v_mfma_f32_16x16x32_bf16 v[152:155], v[116:119], v[192:195], v[152:155]
    s_nop 4
    v_pk_mul_f32 v[180:181], v[140:141], v[120:121]
    v_pk_mul_f32 v[184:185], v[142:143], v[122:123]
    v_pk_mul_f32 v[182:183], v[148:149], v[120:121]
    v_pk_mul_f32 v[186:187], v[150:151], v[122:123]
    v_pk_fma_f32 v[180:181], v[148:149], v[128:129], v[180:181]
    v_pk_fma_f32 v[184:185], v[150:151], v[130:131], v[184:185]
    v_pk_fma_f32 v[182:183], v[140:141], v[128:129], v[182:183] neg_lo:[1,0,0] neg_hi:[1,0,0]
    v_pk_fma_f32 v[186:187], v[142:143], v[130:131], v[186:187] neg_lo:[1,0,0] neg_hi:[1,0,0]
    v_cvt_pk_bf16_f32 v172, v180, v182
    v_cvt_pk_bf16_f32 v174, v184, v186
    v_cvt_pk_bf16_f32 v173, v181, v183
    v_cvt_pk_bf16_f32 v175, v185, v187
    ds_write_b32 v136, v172 offset:0
    ds_write_b32 v136, v174 offset:544
    ds_write_b32 v136, v173 offset:272
    ds_write_b32 v136, v175 offset:816
    v_pk_mul_f32 v[180:181], v[144:145], v[124:125]
    v_pk_mul_f32 v[184:185], v[146:147], v[126:127]
    v_pk_mul_f32 v[182:183], v[152:153], v[124:125]
    v_pk_mul_f32 v[186:187], v[154:155], v[126:127]
    v_pk_fma_f32 v[180:181], v[152:153], v[132:133], v[180:181]
    v_pk_fma_f32 v[184:185], v[154:155], v[134:135], v[184:185]
    v_pk_fma_f32 v[182:183], v[144:145], v[132:133], v[182:183] neg_lo:[1,0,0] neg_hi:[1,0,0]
    v_pk_fma_f32 v[186:187], v[146:147], v[134:135], v[186:187] neg_lo:[1,0,0] neg_hi:[1,0,0]
    v_cvt_pk_bf16_f32 v176, v180, v182
    v_cvt_pk_bf16_f32 v178, v184, v186
    v_cvt_pk_bf16_f32 v177, v181, v183
    v_cvt_pk_bf16_f32 v179, v185, v187
    ds_write_b32 v136, v176 offset:4352
    ds_write_b32 v136, v178 offset:4896
    ds_write_b32 v136, v177 offset:4624
    ds_write_b32 v136, v179 offset:5168
    s_waitcnt lgkmcnt(0)
    s_barrier
    s_mov_b32 s28, s8
    s_mov_b32 s29, s9
    s_mov_b32 s30, 0x21c000
    s_mov_b32 s31, 0x00020000
    s_lshr_b32 s32, s2, 3
    s_mul_i32 s32, s32, 69120
    s_and_b32 s33, s2, 3
    s_mul_i32 s33, s33, 896
    s_add_u32 s32, s32, s33
    s_movk_i32 s33, 9363
    v_mul_u32_u24 v60, s33, v0
    v_lshrrev_b32 v60, 16, v60
    v_mul_u32_u24 v60, 2560, v60
    v_lshl_add_u32 v59, v0, 7, v60
    v_mov_b32 v60, 0x80000000
    v_cmp_gt_u32 vcc, 140, v0
    s_nop 1
    v_cndmask_b32 v59, v60, v59, vcc
    buffer_load_dword v61, v59, s[28:31], s32 offen
    ds_read_b128 v[8:11], v137 offset:0
    ds_read_b128 v[12:15], v137 offset:64
    ds_read_b128 v[16:19], v137 offset:128
    ds_read_b128 v[20:23], v137 offset:192
    ds_read_b128 v[24:27], v137 offset:4352
    ds_read_b128 v[28:31], v137 offset:4416
    ds_read_b128 v[32:35], v137 offset:4480
    ds_read_b128 v[36:39], v137 offset:4544
    s_waitcnt lgkmcnt(7)
    v_mfma_f32_16x16x32_bf16 v[156:159], v[64:67], v[8:11], 0
    v_mfma_f32_16x16x32_bf16 v[164:167], v[80:83], v[8:11], 0
    s_waitcnt lgkmcnt(6)
    v_mfma_f32_16x16x32_bf16 v[156:159], v[68:71], v[12:15], v[156:159]
    v_mfma_f32_16x16x32_bf16 v[164:167], v[84:87], v[12:15], v[164:167]
    s_waitcnt lgkmcnt(5)
    v_mfma_f32_16x16x32_bf16 v[156:159], v[72:75], v[16:19], v[156:159]
    v_mfma_f32_16x16x32_bf16 v[164:167], v[88:91], v[16:19], v[164:167]
    s_waitcnt lgkmcnt(4)
    v_mfma_f32_16x16x32_bf16 v[156:159], v[76:79], v[20:23], v[156:159]
    v_mfma_f32_16x16x32_bf16 v[164:167], v[92:95], v[20:23], v[164:167]
    s_waitcnt lgkmcnt(3)
    v_mfma_f32_16x16x32_bf16 v[160:163], v[64:67], v[24:27], 0
    v_mfma_f32_16x16x32_bf16 v[168:171], v[80:83], v[24:27], 0
    s_waitcnt lgkmcnt(2)
    v_mfma_f32_16x16x32_bf16 v[160:163], v[68:71], v[28:31], v[160:163]
    v_mfma_f32_16x16x32_bf16 v[168:171], v[84:87], v[28:31], v[168:171]
    s_waitcnt lgkmcnt(1)
    v_mfma_f32_16x16x32_bf16 v[160:163], v[72:75], v[32:35], v[160:163]
    v_mfma_f32_16x16x32_bf16 v[168:171], v[88:91], v[32:35], v[168:171]
    s_waitcnt lgkmcnt(0)
    v_mfma_f32_16x16x32_bf16 v[160:163], v[76:79], v[36:39], v[160:163]
    v_mfma_f32_16x16x32_bf16 v[168:171], v[92:95], v[36:39], v[168:171]
    v_cvt_pk_bf16_f32 v192, v156, -v164
    v_cvt_pk_bf16_f32 v193, v157, -v165
    v_cvt_pk_bf16_f32 v194, v158, -v166
    v_cvt_pk_bf16_f32 v195, v159, -v167
    buffer_store_dwordx4 v[192:195], v138, s[24:27], s20 offen offset:0
    s_nop 2
    v_cvt_pk_bf16_f32 v196, v160, -v168
    v_cvt_pk_bf16_f32 v197, v161, -v169
    v_cvt_pk_bf16_f32 v198, v162, -v170
    v_cvt_pk_bf16_f32 v199, v163, -v171
    buffer_store_dwordx4 v[196:199], v138, s[24:27], s20 offen offset:16
    s_endpgm
k2_end:
    s_endpgm
.globl k3_kernel
.p2align 8
.type k3_kernel,@function
k3_kernel:
    s_load_dwordx2 s[4:5], s[0:1], 0
    s_load_dwordx2 s[6:7], s[0:1], 72
    s_load_dwordx4 s[8:11], s[0:1], 32
    s_load_dwordx2 s[30:31], s[0:1], 48
    s_cmp_ge_u32 s2, 256
    s_cbranch_scc1 k3_end
    s_setprio 3
    v_lshrrev_b32 v3, 6, v0
    v_and_b32 v1, 31, v0
    v_readfirstlane_b32 s20, v3
    v_bfe_u32 v2, v0, 5, 1
    s_and_b32 s21, s2, 7
    s_lshl_b32 s21, s21, 5
    s_lshr_b32 s22, s2, 3
    s_add_u32 s21, s21, s22
    v_lshrrev_b32 v7, 1, v0
    v_lshlrev_b32 v9, 13, v7
    v_and_b32 v8, 1, v0
    v_lshl_add_u32 v4, v8, 4, v9
    v_mul_u32_u24 v8, 6144, v8
    v_lshl_add_u32 v6, v7, 2, v8
    s_lshl_b32 s27, s21, 5
    s_add_u32 s28, s27, 0x200000
    s_lshr_b32 s22, s21, 4
    s_lshl_b32 s22, s22, 7
    s_and_b32 s23, s21, 15
    s_add_u32 s22, s22, s23
    s_lshr_b32 s23, s20, 2
    s_lshl_b32 s23, s23, 4
    s_add_u32 s22, s22, s23
    s_and_b32 s23, s20, 3
    s_lshl_b32 s23, s23, 5
    s_add_u32 s22, s22, s23
    s_mul_i32 s24, s22, 1280
    v_lshlrev_b32 v7, 4, v2
    v_lshl_add_u32 v5, v1, 6, v7
    v_mov_b32 v3, 0x80000000
    v_cmp_gt_u32 vcc, 20, v1
    s_nop 1
    v_cndmask_b32 v5, v3, v5, vcc
    s_waitcnt lgkmcnt(0)
    s_add_u32 s12, s6, 0x600000
    s_addc_u32 s13, s7, 0
    s_mov_b32 s14, 0x282000
    s_mov_b32 s15, 0x00020000
    s_mov_b32 s16, s4
    s_mov_b32 s17, s5
    s_mov_b32 s18, 0x280000
    s_mov_b32 s19, 0x00020000
    buffer_load_dwordx4 v[12:15], v4, s[12:15], s27 offen
    buffer_load_dwordx4 v[16:19], v4, s[12:15], s28 offen
    s_setprio 0
    s_add_u32 s32, s6, 0x900000
    s_addc_u32 s33, s7, 0
    s_mov_b32 s34, 0x280000
    s_mov_b32 s35, 0x00020000
    s_add_u32 s36, s6, 0xc00000
    s_addc_u32 s37, s7, 0
    s_mov_b32 s38, 0x280000
    s_mov_b32 s39, 0x00020000
    v_and_b32 v29, 63, v0
    v_cvt_f32_u32 v28, v1
    v_lshlrev_b32 v29, 4, v29
    v_mul_f32 v30, 0x3d000000, v28
    s_add_u32 s40, s20, 0
    s_lshr_b32 s47, s40, 2
    s_lshl_b32 s47, s47, 10
    s_and_b32 s40, s40, 3
    s_lshl_b32 s40, s40, 2
    s_add_u32 s40, s40, s47
    s_lshr_b32 s47, s20, 2
    s_lshl_b32 s47, s47, 3
    s_and_b32 s41, s20, 3
    s_add_u32 s41, s41, s47
    v_lshl_add_u32 v7, v2, 2, s41
    v_cvt_f32_u32 v7, v7
    v_mul_f32 v7, v7, v30
    v_cos_f32 v8, v7
    v_sin_f32 v10, v7
    v_add_u32 v31, s40, v29
    v_cvt_pk_bf16_f32 v9, v8, -v10
    v_cvt_pk_bf16_f32 v7, v10, v8
    ds_write_b32 v31, v9 offset:12288
    ds_write_b32 v31, v7 offset:14336
    v_mul_f32 v30, 0x3acccccd, v28
    s_lshr_b32 s47, s20, 2
    s_lshl_b32 s47, s47, 3
    s_and_b32 s41, s20, 3
    s_add_u32 s41, s41, s47
    s_add_u32 s40, s20, 28
    s_lshr_b32 s47, s40, 2
    s_lshl_b32 s47, s47, 10
    s_and_b32 s40, s40, 3
    s_lshl_b32 s40, s40, 2
    s_add_u32 s40, s40, s47
    v_lshl_add_u32 v7, v2, 2, s41
    v_cvt_f32_u32 v7, v7
    v_mul_f32 v7, v7, v30
    v_add_u32 v31, s40, v29
    v_cos_f32 v8, v7
    v_sin_f32 v9, v7
    s_nop 0
    ds_write_b32 v31, v8 offset:12288
    ds_write_b32 v31, v9 offset:15360
    s_and_b32 s42, s20, 3
    s_add_u32 s42, s42, 8
    s_lshr_b32 s47, s42, 2
    s_lshl_b32 s47, s47, 3
    s_and_b32 s41, s42, 3
    s_add_u32 s41, s41, s47
    s_add_u32 s40, s42, 28
    s_lshr_b32 s47, s40, 2
    s_lshl_b32 s47, s47, 10
    s_and_b32 s40, s40, 3
    s_lshl_b32 s40, s40, 2
    s_add_u32 s40, s40, s47
    v_lshl_add_u32 v7, v2, 2, s41
    v_cvt_f32_u32 v7, v7
    v_mul_f32 v7, v7, v30
    v_add_u32 v31, s40, v29
    v_cos_f32 v8, v7
    v_sin_f32 v9, v7
    s_nop 0
    ds_write_b32 v31, v8 offset:12288
    ds_write_b32 v31, v9 offset:15360
    s_min_u32 s46, s20, 5
    s_lshl_b32 s42, s46, 1
    s_lshr_b32 s47, s42, 2
    s_lshl_b32 s47, s47, 3
    s_and_b32 s41, s42, 3
    s_add_u32 s41, s41, s47
    s_cmp_ge_u32 s46, 4
    s_cselect_b32 s42, 4, 0
    s_cselect_b32 s43, 6, 4
    s_add_u32 s42, s42, s46
    s_add_u32 s43, s43, s46
    s_cmp_ge_u32 s46, 4
    s_mov_b32 vcc_lo, 0xfffff
    s_cselect_b32 vcc_hi, 0, 0xfffff
    v_mul_f32 v30, 0x3d4ccccd, v28
    s_add_u32 s44, s42, 16
    s_lshr_b32 s47, s44, 2
    s_lshl_b32 s47, s47, 10
    s_and_b32 s44, s44, 3
    s_lshl_b32 s44, s44, 2
    s_add_u32 s44, s44, s47
    s_add_u32 s45, s43, 16
    s_lshr_b32 s47, s45, 2
    s_lshl_b32 s47, s47, 10
    s_and_b32 s45, s45, 3
    s_lshl_b32 s45, s45, 2
    s_add_u32 s45, s45, s47
    v_lshl_add_u32 v7, v2, 2, s41
    v_cvt_f32_u32 v7, v7
    v_mul_f32 v7, v7, v30
    v_add_f32 v8, v7, v30
    v_cos_f32 v9, v7
    v_cos_f32 v10, v8
    v_sin_f32 v7, v7
    v_sin_f32 v8, v8
    v_add_u32 v30, s44, v29
    v_add_u32 v31, s45, v29
    v_cvt_pk_bf16_f32 v9, v9, v10
    v_cvt_pk_bf16_f32 v7, -v7, -v8
    s_cmp_eq_u32 s46, 4
    s_cselect_b32 s46, 0x3f80, 0
    v_mov_b32 v10, s46
    v_cmp_gt_u32 s[42:43], 20, v1
    s_nop 1
    v_cndmask_b32 v10, 0, v10, s[42:43]
    v_cndmask_b32 v9, v10, v9, vcc
    v_cndmask_b32 v7, 0, v7, vcc
    ds_write_b32 v30, v9 offset:12288
    ds_write_b32 v31, v7 offset:12288
    buffer_load_dwordx4 v[20:23], v5, s[16:19], s24 offen offset:0
    buffer_load_dwordx4 v[24:27], v5, s[16:19], s24 offen offset:32
    v_min_u32 v7, 19, v1
    v_mul_u32_u24 v8, 80, v2
    v_add_lshl_u32 v84, v7, v8, 2
    s_mul_i32 s26, s20, 1536
    v_add_u32 v84, s26, v84
    v_mov_b32 v85, s26
    v_lshlrev_b32 v86, 31, v0
    s_waitcnt vmcnt(3)
    ds_write2st64_b32 v6, v12, v13 offset0:0 offset1:6
    ds_write2st64_b32 v6, v14, v15 offset0:12 offset1:18
    s_waitcnt vmcnt(2)
    s_cmp_ge_u32 s20, 4
    s_cbranch_scc1 k3_w1
    ds_write2st64_b32 v6, v16, v17 offset0:4 offset1:10
    ds_write2st64_b32 v6, v18, v19 offset0:16 offset1:22
k3_w1:
    s_waitcnt lgkmcnt(0)
    s_barrier
    ds_read2_b32 v[88:89], v84 offset0:0 offset1:20
    ds_read2_b32 v[90:91], v84 offset0:40 offset1:60
    ds_read2_b32 v[92:93], v84 offset0:160 offset1:180
    ds_read2_b32 v[94:95], v84 offset0:200 offset1:220
    ds_read_b128 v[32:35], v29 offset:12288
    ds_read_b128 v[36:39], v29 offset:13312
    ds_read_b128 v[40:43], v29 offset:14336
    ds_read_b128 v[44:47], v29 offset:15360
    ds_read_b128 v[48:51], v29 offset:16384
    ds_read_b128 v[52:55], v29 offset:17408
    ds_read_b128 v[56:59], v29 offset:18432
    ds_read_b128 v[60:63], v29 offset:19456
    ds_read_b128 v[64:67], v29 offset:20480
    ds_read_b128 v[68:71], v29 offset:21504
    ds_read_b128 v[72:75], v29 offset:22528
    ds_read_b128 v[76:79], v29 offset:23552
    ds_read_b128 v[80:83], v29 offset:24576
    ds_read_b32 v96, v85 offset:1280
    s_waitcnt vmcnt(0)
    s_mov_b32 s48, s10
    s_mov_b32 s49, s11
    s_mov_b32 s50, 0x21c000
    s_mov_b32 s51, 0x00020000
    s_lshr_b32 s25, s2, 3
    s_mul_i32 s25, s25, 69120
    s_and_b32 s26, s2, 3
    s_mul_i32 s26, s26, 896
    s_add_u32 s25, s25, s26
    s_movk_i32 s26, 9363
    v_mul_u32_u24 v8, s26, v0
    v_lshrrev_b32 v8, 16, v8
    v_mul_u32_u24 v8, 2560, v8
    v_lshl_add_u32 v7, v0, 7, v8
    v_mov_b32 v8, 0x80000000
    v_cmp_gt_u32 vcc, 140, v0
    s_nop 1
    v_cndmask_b32 v7, v8, v7, vcc
    buffer_load_dword v3, v7, s[48:51], s25 offen
    v_cmp_eq_u32 vcc, 1, v2
    v_permlane32_swap_b32 v20, v22
    v_permlane32_swap_b32 v21, v23
    v_permlane32_swap_b32 v24, v26
    v_permlane32_swap_b32 v25, v27
    s_waitcnt lgkmcnt(10)
    v_mfma_f32_32x32x16_bf16 v[100:115], v[88:91], v[32:35], 0
    v_mfma_f32_32x32x16_bf16 v[116:131], v[88:91], v[40:43], 0
    v_mfma_f32_32x32x16_bf16 v[100:115], v[92:95], v[36:39], v[100:115]
    v_mfma_f32_32x32x16_bf16 v[116:131], v[92:95], v[44:47], v[116:131]
    s_waitcnt lgkmcnt(0)
    v_lshlrev_b32 v96, 16, v96
    v_xor_b32 v96, v86, v96
    s_nop 7
    v_pk_mul_f32 v[160:161], v[100:101], v[60:61]
    v_pk_mul_f32 v[164:165], v[102:103], v[62:63]
    v_pk_mul_f32 v[162:163], v[116:117], v[60:61]
    v_pk_mul_f32 v[166:167], v[118:119], v[62:63]
    v_pk_fma_f32 v[160:161], v[116:117], v[72:73], v[160:161] neg_lo:[1,0,0] neg_hi:[1,0,0]
    v_pk_fma_f32 v[164:165], v[118:119], v[74:75], v[164:165] neg_lo:[1,0,0] neg_hi:[1,0,0]
    v_pk_fma_f32 v[162:163], v[100:101], v[72:73], v[162:163]
    v_pk_fma_f32 v[166:167], v[102:103], v[74:75], v[166:167]
    v_cvt_pk_bf16_f32 v136, v162, v163
    v_cvt_pk_bf16_f32 v137, v166, v167
    v_cvt_pk_bf16_f32 v132, v160, v161
    v_cvt_pk_bf16_f32 v133, v164, v165
    v_pk_mul_f32 v[160:161], v[104:105], v[64:65]
    v_pk_mul_f32 v[164:165], v[106:107], v[66:67]
    v_pk_mul_f32 v[162:163], v[120:121], v[64:65]
    v_pk_mul_f32 v[166:167], v[122:123], v[66:67]
    v_pk_fma_f32 v[160:161], v[120:121], v[76:77], v[160:161] neg_lo:[1,0,0] neg_hi:[1,0,0]
    v_pk_fma_f32 v[164:165], v[122:123], v[78:79], v[164:165] neg_lo:[1,0,0] neg_hi:[1,0,0]
    v_pk_fma_f32 v[162:163], v[104:105], v[76:77], v[162:163]
    v_pk_fma_f32 v[166:167], v[106:107], v[78:79], v[166:167]
    v_cvt_pk_bf16_f32 v138, v162, v163
    v_cvt_pk_bf16_f32 v139, v166, v167
    v_cvt_pk_bf16_f32 v134, v160, v161
    v_cvt_pk_bf16_f32 v135, v164, v165
    s_nop 1
    v_mfma_f32_32x32x16_bf16 v[144:159], v[132:135], v[48:51], 0
    v_mfma_f32_32x32x16_bf16 v[144:159], v[136:139], v[52:55], v[144:159]
    v_pk_mul_f32 v[160:161], v[108:109], v[68:69]
    v_pk_mul_f32 v[164:165], v[110:111], v[70:71]
    v_pk_mul_f32 v[162:163], v[124:125], v[68:69]
    v_pk_mul_f32 v[166:167], v[126:127], v[70:71]
    v_pk_fma_f32 v[160:161], v[124:125], v[80:81], v[160:161] neg_lo:[1,0,0] neg_hi:[1,0,0]
    v_pk_fma_f32 v[164:165], v[126:127], v[82:83], v[164:165] neg_lo:[1,0,0] neg_hi:[1,0,0]
    v_pk_fma_f32 v[162:163], v[108:109], v[80:81], v[162:163]
    v_pk_fma_f32 v[166:167], v[110:111], v[82:83], v[166:167]
    v_cndmask_b32 v160, v160, v96, vcc
    v_cvt_pk_bf16_f32 v142, v162, v163
    v_cvt_pk_bf16_f32 v143, v166, v167
    v_cvt_pk_bf16_f32 v140, v160, v161
    v_cvt_pk_bf16_f32 v141, v164, v165
    s_nop 1
    v_mfma_f32_32x32x16_bf16 v[144:159], v[140:143], v[56:59], v[144:159]
    v_lshlrev_b32 v100, 16, v20
    v_and_b32 v101, 0xffff0000, v20
    v_lshlrev_b32 v102, 16, v21
    v_and_b32 v103, 0xffff0000, v21
    v_lshlrev_b32 v104, 16, v22
    v_and_b32 v105, 0xffff0000, v22
    v_lshlrev_b32 v106, 16, v23
    v_and_b32 v107, 0xffff0000, v23
    v_lshlrev_b32 v108, 16, v24
    v_and_b32 v109, 0xffff0000, v24
    v_lshlrev_b32 v110, 16, v25
    v_and_b32 v111, 0xffff0000, v25
    v_lshlrev_b32 v112, 16, v26
    v_and_b32 v113, 0xffff0000, v26
    v_lshlrev_b32 v114, 16, v27
    v_and_b32 v115, 0xffff0000, v27
    v_cvt_pk_bf16_f32 v144, 0, v144
    v_cvt_pk_bf16_f32 v146, 0, v146
    v_cvt_pk_bf16_f32 v145, 0, v145
    v_cvt_pk_bf16_f32 v147, 0, v147
    v_pk_add_f32 v[144:145], v[144:145], v[100:101]
    v_pk_add_f32 v[146:147], v[146:147], v[102:103]
    v_cvt_pk_bf16_f32 v88, v144, v145
    v_cvt_pk_bf16_f32 v89, v146, v147
    v_cvt_pk_bf16_f32 v144, 0, v144
    v_cvt_pk_bf16_f32 v146, 0, v146
    v_cvt_pk_bf16_f32 v145, 0, v145
    v_cvt_pk_bf16_f32 v147, 0, v147
    v_pk_mul_f32 v[162:163], v[144:145], v[144:145]
    v_pk_mul_f32 v[166:167], v[146:147], v[146:147]
    v_cvt_pk_bf16_f32 v148, 0, v148
    v_cvt_pk_bf16_f32 v150, 0, v150
    v_cvt_pk_bf16_f32 v149, 0, v149
    v_cvt_pk_bf16_f32 v151, 0, v151
    v_pk_add_f32 v[148:149], v[148:149], v[104:105]
    v_pk_add_f32 v[150:151], v[150:151], v[106:107]
    v_cvt_pk_bf16_f32 v90, v148, v149
    v_cvt_pk_bf16_f32 v91, v150, v151
    v_cvt_pk_bf16_f32 v148, 0, v148
    v_cvt_pk_bf16_f32 v150, 0, v150
    v_cvt_pk_bf16_f32 v149, 0, v149
    v_cvt_pk_bf16_f32 v151, 0, v151
    v_pk_fma_f32 v[162:163], v[148:149], v[148:149], v[162:163]
    v_pk_fma_f32 v[166:167], v[150:151], v[150:151], v[166:167]
    v_pk_add_f32 v[160:161], v[144:145], v[148:149]
    v_pk_add_f32 v[164:165], v[146:147], v[150:151]
    v_cvt_pk_bf16_f32 v152, 0, v152
    v_cvt_pk_bf16_f32 v154, 0, v154
    v_cvt_pk_bf16_f32 v153, 0, v153
    v_cvt_pk_bf16_f32 v155, 0, v155
    v_pk_add_f32 v[152:153], v[152:153], v[108:109]
    v_pk_add_f32 v[154:155], v[154:155], v[110:111]
    v_cvt_pk_bf16_f32 v92, v152, v153
    v_cvt_pk_bf16_f32 v93, v154, v155
    v_cvt_pk_bf16_f32 v152, 0, v152
    v_cvt_pk_bf16_f32 v154, 0, v154
    v_cvt_pk_bf16_f32 v153, 0, v153
    v_cvt_pk_bf16_f32 v155, 0, v155
    v_pk_fma_f32 v[162:163], v[152:153], v[152:153], v[162:163]
    v_pk_fma_f32 v[166:167], v[154:155], v[154:155], v[166:167]
    v_pk_add_f32 v[160:161], v[160:161], v[152:153]
    v_pk_add_f32 v[164:165], v[164:165], v[154:155]
    v_cvt_pk_bf16_f32 v156, 0, v156
    v_cvt_pk_bf16_f32 v158, 0, v158
    v_cvt_pk_bf16_f32 v157, 0, v157
    v_cvt_pk_bf16_f32 v159, 0, v159
    v_pk_add_f32 v[156:157], v[156:157], v[112:113]
    v_pk_add_f32 v[158:159], v[158:159], v[114:115]
    v_cvt_pk_bf16_f32 v94, v156, v157
    v_cvt_pk_bf16_f32 v95, v158, v159
    v_cvt_pk_bf16_f32 v156, 0, v156
    v_cvt_pk_bf16_f32 v158, 0, v158
    v_cvt_pk_bf16_f32 v157, 0, v157
    v_cvt_pk_bf16_f32 v159, 0, v159
    v_pk_fma_f32 v[162:163], v[156:157], v[156:157], v[162:163]
    v_pk_fma_f32 v[166:167], v[158:159], v[158:159], v[166:167]
    v_pk_add_f32 v[160:161], v[160:161], v[156:157]
    v_pk_add_f32 v[164:165], v[164:165], v[158:159]
    v_pk_add_f32 v[160:161], v[160:161], v[164:165]
    v_pk_add_f32 v[162:163], v[162:163], v[166:167]
    v_add_f32 v168, v160, v161
    v_add_f32 v169, v162, v163
    s_nop 1
    v_permlane32_swap_b32 v168, v169
    v_add_f32 v168, v168, v169
    v_mov_b32 v169, v168
    s_nop 1
    v_permlane16_swap_b32 v168, v169
    v_add_f32 v168, v168, v169
    s_nop 1
    v_add_f32_dpp v168, v168, v168 quad_perm:[1,0,3,2] row_mask:0xf bank_mask:0xf
    s_nop 1
    v_add_f32_dpp v168, v168, v168 quad_perm:[2,3,0,1] row_mask:0xf bank_mask:0xf
    s_nop 1
    v_add_f32_dpp v168, v168, v168 row_half_mirror row_mask:0xf bank_mask:0xf
    s_nop 1
    v_add_f32_dpp v168, v168, v168 row_mirror row_mask:0xf bank_mask:0xf
    s_nop 0
    v_readlane_b32 s40, v168, 0
    v_readlane_b32 s41, v168, 32
    v_permlane32_swap_b32 v88, v90
    v_permlane32_swap_b32 v89, v91
    buffer_store_dwordx4 v[88:91], v5, s[32:35], s24 offen offset:0
    v_permlane32_swap_b32 v92, v94
    v_permlane32_swap_b32 v93, v95
    buffer_store_dwordx4 v[92:95], v5, s[32:35], s24 offen offset:32
    v_mov_b32 v7, s40
    v_mov_b32 v8, s41
    v_mul_f32 v7, 0x3acccccd, v7
    v_mul_f32 v8, 0x3acccccd, v8
    v_fma_f32 v8, -v7, v7, v8
    v_cvt_pk_bf16_f32 v7, v7, v8
    v_lshlrev_b32 v170, 16, v7
    v_and_b32 v8, 0xffff0000, v7
    v_add_f32 v8, 0x3727c5ac, v8
    v_cvt_pk_bf16_f32 v8, v8, v8
    v_and_b32 v8, 0xffff0000, v8
    v_sqrt_f32 v7, v8
    s_nop 0
    v_cvt_pk_bf16_f32 v7, v7, v7
    v_and_b32 v7, 0xffff0000, v7
    v_rcp_f32 v171, v7
    s_nop 0
    v_fma_f32 v8, -v7, v171, 2.0
    v_mul_f32 v171, v171, v8
    v_pk_add_f32 v[144:145], v[144:145], v[170:171] op_sel_hi:[1,0] neg_lo:[0,1] neg_hi:[0,1]
    v_pk_add_f32 v[146:147], v[146:147], v[170:171] op_sel_hi:[1,0] neg_lo:[0,1] neg_hi:[0,1]
    v_pk_add_f32 v[148:149], v[148:149], v[170:171] op_sel_hi:[1,0] neg_lo:[0,1] neg_hi:[0,1]
    v_pk_add_f32 v[150:151], v[150:151], v[170:171] op_sel_hi:[1,0] neg_lo:[0,1] neg_hi:[0,1]
    v_cvt_pk_bf16_f32 v144, 0, v144
    v_cvt_pk_bf16_f32 v146, 0, v146
    v_cvt_pk_bf16_f32 v148, 0, v148
    v_cvt_pk_bf16_f32 v150, 0, v150
    v_cvt_pk_bf16_f32 v145, 0, v145
    v_cvt_pk_bf16_f32 v147, 0, v147
    v_cvt_pk_bf16_f32 v149, 0, v149
    v_cvt_pk_bf16_f32 v151, 0, v151
    v_pk_mul_f32 v[144:145], v[144:145], v[170:171] op_sel:[0,1] op_sel_hi:[1,1]
    v_pk_mul_f32 v[146:147], v[146:147], v[170:171] op_sel:[0,1] op_sel_hi:[1,1]
    v_pk_mul_f32 v[148:149], v[148:149], v[170:171] op_sel:[0,1] op_sel_hi:[1,1]
    v_pk_mul_f32 v[150:151], v[150:151], v[170:171] op_sel:[0,1] op_sel_hi:[1,1]
    v_cvt_pk_bf16_f32 v20, v144, v145
    v_cvt_pk_bf16_f32 v21, v146, v147
    v_cvt_pk_bf16_f32 v22, v148, v149
    v_cvt_pk_bf16_f32 v23, v150, v151
    s_nop 0
    v_permlane32_swap_b32 v20, v22
    v_permlane32_swap_b32 v21, v23
    buffer_store_dwordx4 v[20:23], v5, s[36:39], s24 offen offset:0
    v_pk_add_f32 v[152:153], v[152:153], v[170:171] op_sel_hi:[1,0] neg_lo:[0,1] neg_hi:[0,1]
    v_pk_add_f32 v[154:155], v[154:155], v[170:171] op_sel_hi:[1,0] neg_lo:[0,1] neg_hi:[0,1]
    v_pk_add_f32 v[156:157], v[156:157], v[170:171] op_sel_hi:[1,0] neg_lo:[0,1] neg_hi:[0,1]
    v_pk_add_f32 v[158:159], v[158:159], v[170:171] op_sel_hi:[1,0] neg_lo:[0,1] neg_hi:[0,1]
    v_cvt_pk_bf16_f32 v152, 0, v152
    v_cvt_pk_bf16_f32 v154, 0, v154
    v_cvt_pk_bf16_f32 v156, 0, v156
    v_cvt_pk_bf16_f32 v158, 0, v158
    v_cvt_pk_bf16_f32 v153, 0, v153
    v_cvt_pk_bf16_f32 v155, 0, v155
    v_cvt_pk_bf16_f32 v157, 0, v157
    v_cvt_pk_bf16_f32 v159, 0, v159
    v_pk_mul_f32 v[152:153], v[152:153], v[170:171] op_sel:[0,1] op_sel_hi:[1,1]
    v_pk_mul_f32 v[154:155], v[154:155], v[170:171] op_sel:[0,1] op_sel_hi:[1,1]
    v_pk_mul_f32 v[156:157], v[156:157], v[170:171] op_sel:[0,1] op_sel_hi:[1,1]
    v_pk_mul_f32 v[158:159], v[158:159], v[170:171] op_sel:[0,1] op_sel_hi:[1,1]
    v_cvt_pk_bf16_f32 v24, v152, v153
    v_cvt_pk_bf16_f32 v25, v154, v155
    v_cvt_pk_bf16_f32 v26, v156, v157
    v_cvt_pk_bf16_f32 v27, v158, v159
    s_nop 0
    v_permlane32_swap_b32 v24, v26
    v_permlane32_swap_b32 v25, v27
    buffer_store_dwordx4 v[24:27], v5, s[36:39], s24 offen offset:32
k3_end:
    s_endpgm
.globl k4_kernel
.p2align 8
.type k4_kernel,@function
k4_kernel:
    s_load_dwordx4 s[4:7], s[0:1], 32
    s_load_dwordx2 s[8:9], s[0:1], 72
    s_and_b32 s40, s2, 7
    s_lshr_b32 s41, s2, 3
    s_lshr_b32 s42, s40, 2
    s_lshl_b32 s42, s42, 2
    s_and_b32 s43, s41, 3
    s_add_u32 s42, s42, s43
    s_and_b32 s43, s40, 3
    s_mul_i32 s43, s43, 7
    s_lshr_b32 s44, s41, 2
    s_add_u32 s43, s43, s44
    s_cmp_ge_u32 s2, 224
    s_cbranch_scc1 k4_pk
    s_cmp_ge_u32 s43, 27
    s_cbranch_scc1 k4_end
    v_lshrrev_b32 v2, 6, v0
    v_and_b32 v1, 63, v0
    v_readfirstlane_b32 s28, v2
    v_lshrrev_b32 v6, 4, v1
    v_mov_b32 v16, 147456
    s_lshl_b32 s29, s43, 7
    s_mul_i32 s30, s42, 327680
    s_and_b32 s45, s41, 3
    s_mul_i32 s45, s45, 1
    s_add_u32 s44, s44, s45
    s_cmp_ge_u32 s44, 2
    s_cselect_b32 s45, 2, 0
    s_sub_u32 s44, s44, s45
    s_cmp_ge_u32 s44, 2
    s_cselect_b32 s45, 2, 0
    s_sub_u32 s44, s44, s45
    s_cmp_ge_u32 s44, 2
    s_cselect_b32 s45, 2, 0
    s_sub_u32 s44, s44, s45
    s_cmp_ge_u32 s44, 2
    s_cselect_b32 s45, 2, 0
    s_sub_u32 s44, s44, s45
    s_mul_i32 s44, s44, 5
    s_mul_i32 s45, s44, 221184
    s_add_u32 s29, s29, s45
    s_lshl_b32 s45, s44, 7
    s_add_u32 s30, s30, s45
    s_cmp_ge_u32 s28, 8
    s_cbranch_scc1 k4_prod
    v_and_b32 v2, 3, v1
    v_lshrrev_b32 v3, 1, v2
    v_xor_b32 v2, v2, v3
    v_bfe_u32 v3, v1, 2, 2
    v_lshl_add_u32 v4, v6, 3, v3
    v_lshlrev_b32 v9, 7, v4
    v_and_b32 v3, 2, v3
    v_and_b32 v4, 1, v6
    v_lshl_or_b32 v3, v4, 2, v3
    s_lshr_b32 s45, s28, 2
    s_lshl_b32 s45, s45, 2
    v_lshrrev_b32 v4, 1, v2
    v_or_b32 v4, s45, v4
    v_xor_b32 v4, v4, v3
    v_lshl_add_u32 v9, v4, 4, v9
    v_and_b32 v2, 1, v2
    v_lshl_add_u32 v9, v2, 3, v9
    v_and_b32 v2, 15, v1
    v_and_b32 v3, 7, v1
    v_xor_b32 v3, v3, v6
    v_lshlrev_b32 v3, 4, v3
    v_lshl_add_u32 v10, v2, 7, v3
    s_and_b32 s46, s28, 3
    s_lshl_b32 s46, s46, 13
    v_add_u32 v10, s46, v10
    s_lshl_b32 s46, s42, 8
    s_and_b32 s47, s28, 3
    s_lshl_b32 s47, s47, 6
    s_add_u32 s46, s46, s47
    s_mul_i32 s46, s46, 3456
    s_lshl_b32 s47, s43, 7
    s_add_u32 s46, s46, s47
    s_lshl_b32 s47, s45, 4
    s_add_u32 s39, s46, s47
    v_mul_u32_u24 v15, 3456, v2
    v_and_b32 v3, 1, v6
    v_lshl_add_u32 v15, v3, 5, v15
    v_lshrrev_b32 v3, 1, v6
    v_lshl_add_u32 v15, v3, 4, v15
    v_mov_b32 v20, 0
    v_mov_b32 v21, 0
    v_mov_b32 v22, 0
    v_mov_b32 v23, 0
    v_mov_b32 v24, 0
    v_mov_b32 v25, 0
    v_mov_b32 v26, 0
    v_mov_b32 v27, 0
    v_mov_b32 v28, 0
    v_mov_b32 v29, 0
    v_mov_b32 v30, 0
    v_mov_b32 v31, 0
    v_mov_b32 v32, 0
    v_mov_b32 v33, 0
    v_mov_b32 v34, 0
    v_mov_b32 v35, 0
    v_mov_b32 v36, 0
    v_mov_b32 v37, 0
    v_mov_b32 v38, 0
    v_mov_b32 v39, 0
    v_mov_b32 v40, 0
    v_mov_b32 v41, 0
    v_mov_b32 v42, 0
    v_mov_b32 v43, 0
    v_mov_b32 v44, 0
    v_mov_b32 v45, 0
    v_mov_b32 v46, 0
    v_mov_b32 v47, 0
    v_mov_b32 v48, 0
    v_mov_b32 v49, 0
    v_mov_b32 v50, 0
    v_mov_b32 v51, 0
    v_mov_b32 v52, 0
    v_mov_b32 v53, 0
    v_mov_b32 v54, 0
    v_mov_b32 v55, 0
    v_mov_b32 v56, 0
    v_mov_b32 v57, 0
    v_mov_b32 v58, 0
    v_mov_b32 v59, 0
    v_mov_b32 v60, 0
    v_mov_b32 v61, 0
    v_mov_b32 v62, 0
    v_mov_b32 v63, 0
    v_mov_b32 v64, 0
    v_mov_b32 v65, 0
    v_mov_b32 v66, 0
    v_mov_b32 v67, 0
    v_mov_b32 v68, 0
    v_mov_b32 v69, 0
    v_mov_b32 v70, 0
    v_mov_b32 v71, 0
    v_mov_b32 v72, 0
    v_mov_b32 v73, 0
    v_mov_b32 v74, 0
    v_mov_b32 v75, 0
    v_mov_b32 v76, 0
    v_mov_b32 v77, 0
    v_mov_b32 v78, 0
    v_mov_b32 v79, 0
    v_mov_b32 v80, 0
    v_mov_b32 v81, 0
    v_mov_b32 v82, 0
    v_mov_b32 v83, 0
    v_mov_b32 v11, v9
    v_xor_b32 v12, 32, v9
    v_mov_b32 v13, v10
    v_xor_b32 v14, 64, v10
    s_mov_b32 s34, 0
    s_mov_b32 s35, 0
    s_waitcnt lgkmcnt(0)
    s_add_u32 s24, s8, 0x1000000
    s_addc_u32 s25, s9, 0
    s_mov_b32 s26, 0x6c0000
    s_mov_b32 s27, 0x00020000
    s_barrier
    ds_read_b64_tr_b16 v[84:85], v11 offset:0
    ds_read_b64_tr_b16 v[86:87], v11 offset:512
    ds_read_b128 v[116:119], v13 offset:16384
    ds_read_b64_tr_b16 v[88:89], v12 offset:0
    ds_read_b64_tr_b16 v[90:91], v12 offset:512
    ds_read_b128 v[120:123], v13 offset:18432
    ds_read_b64_tr_b16 v[92:93], v11 offset:8192
    ds_read_b64_tr_b16 v[94:95], v11 offset:8704
    ds_read_b128 v[124:127], v13 offset:20480
    ds_read_b64_tr_b16 v[96:97], v12 offset:8192
    ds_read_b64_tr_b16 v[98:99], v12 offset:8704
    ds_read_b128 v[128:131], v13 offset:22528
k4_loop:
    s_waitcnt lgkmcnt(0)
    v_mfma_f32_16x16x32_bf16 v[20:23], v[84:87], v[116:119], v[20:23]
    ds_read_b64_tr_b16 v[100:101], v11 offset:4096
    v_mfma_f32_16x16x32_bf16 v[24:27], v[88:91], v[116:119], v[24:27]
    ds_read_b64_tr_b16 v[102:103], v11 offset:4608
    v_mfma_f32_16x16x32_bf16 v[28:31], v[92:95], v[116:119], v[28:31]
    ds_read_b128 v[132:135], v14 offset:16384
    v_mfma_f32_16x16x32_bf16 v[32:35], v[96:99], v[116:119], v[32:35]
    ds_read_b64_tr_b16 v[104:105], v12 offset:4096
    v_mfma_f32_16x16x32_bf16 v[36:39], v[84:87], v[120:123], v[36:39]
    ds_read_b64_tr_b16 v[106:107], v12 offset:4608
    v_mfma_f32_16x16x32_bf16 v[40:43], v[88:91], v[120:123], v[40:43]
    ds_read_b128 v[136:139], v14 offset:18432
    v_mfma_f32_16x16x32_bf16 v[44:47], v[92:95], v[120:123], v[44:47]
    ds_read_b64_tr_b16 v[108:109], v11 offset:12288
    v_mfma_f32_16x16x32_bf16 v[48:51], v[96:99], v[120:123], v[48:51]
    ds_read_b64_tr_b16 v[110:111], v11 offset:12800
    v_mfma_f32_16x16x32_bf16 v[52:55], v[84:87], v[124:127], v[52:55]
    ds_read_b128 v[140:143], v14 offset:20480
    v_mfma_f32_16x16x32_bf16 v[56:59], v[88:91], v[124:127], v[56:59]
    ds_read_b64_tr_b16 v[112:113], v12 offset:12288
    v_mfma_f32_16x16x32_bf16 v[60:63], v[92:95], v[124:127], v[60:63]
    ds_read_b64_tr_b16 v[114:115], v12 offset:12800
    v_mfma_f32_16x16x32_bf16 v[64:67], v[96:99], v[124:127], v[64:67]
    ds_read_b128 v[144:147], v14 offset:22528
    v_mfma_f32_16x16x32_bf16 v[68:71], v[84:87], v[128:131], v[68:71]
    s_add_u32 s36, s34, 49152
    s_cmp_ge_u32 s36, 147456
    s_cselect_b32 s36, 0, s36
    v_mfma_f32_16x16x32_bf16 v[72:75], v[88:91], v[128:131], v[72:75]
    v_add_u32 v11, s36, v9
    v_add_u32 v13, s36, v10
    v_mfma_f32_16x16x32_bf16 v[76:79], v[92:95], v[128:131], v[76:79]
    v_xor_b32 v12, 32, v11
    v_xor_b32 v14, 64, v13
    v_mfma_f32_16x16x32_bf16 v[80:83], v[96:99], v[128:131], v[80:83]
    s_waitcnt lgkmcnt(0)
    s_barrier
    v_mfma_f32_16x16x32_bf16 v[20:23], v[100:103], v[132:135], v[20:23]
    ds_read_b64_tr_b16 v[84:85], v11 offset:0
    v_mfma_f32_16x16x32_bf16 v[24:27], v[104:107], v[132:135], v[24:27]
    ds_read_b64_tr_b16 v[86:87], v11 offset:512
    v_mfma_f32_16x16x32_bf16 v[28:31], v[108:111], v[132:135], v[28:31]
    ds_read_b128 v[116:119], v13 offset:16384
    v_mfma_f32_16x16x32_bf16 v[32:35], v[112:115], v[132:135], v[32:35]
    ds_read_b64_tr_b16 v[88:89], v12 offset:0
    v_mfma_f32_16x16x32_bf16 v[36:39], v[100:103], v[136:139], v[36:39]
    ds_read_b64_tr_b16 v[90:91], v12 offset:512
    v_mfma_f32_16x16x32_bf16 v[40:43], v[104:107], v[136:139], v[40:43]
    ds_read_b128 v[120:123], v13 offset:18432
    v_mfma_f32_16x16x32_bf16 v[44:47], v[108:111], v[136:139], v[44:47]
    ds_read_b64_tr_b16 v[92:93], v11 offset:8192
    v_mfma_f32_16x16x32_bf16 v[48:51], v[112:115], v[136:139], v[48:51]
    ds_read_b64_tr_b16 v[94:95], v11 offset:8704
    v_mfma_f32_16x16x32_bf16 v[52:55], v[100:103], v[140:143], v[52:55]
    ds_read_b128 v[124:127], v13 offset:20480
    v_mfma_f32_16x16x32_bf16 v[56:59], v[104:107], v[140:143], v[56:59]
    ds_read_b64_tr_b16 v[96:97], v12 offset:8192
    v_mfma_f32_16x16x32_bf16 v[60:63], v[108:111], v[140:143], v[60:63]
    ds_read_b64_tr_b16 v[98:99], v12 offset:8704
    v_mfma_f32_16x16x32_bf16 v[64:67], v[112:115], v[140:143], v[64:67]
    ds_read_b128 v[128:131], v13 offset:22528
    v_mfma_f32_16x16x32_bf16 v[68:71], v[100:103], v[144:147], v[68:71]
    v_mfma_f32_16x16x32_bf16 v[72:75], v[104:107], v[144:147], v[72:75]
    v_mfma_f32_16x16x32_bf16 v[76:79], v[108:111], v[144:147], v[76:79]
    v_mfma_f32_16x16x32_bf16 v[80:83], v[112:115], v[144:147], v[80:83]
    s_mov_b32 s34, s36
    s_add_u32 s35, s35, 1
    s_cmp_lt_u32 s35, 10
    s_cbranch_scc1 k4_loop
    s_waitcnt lgkmcnt(0)
    s_mov_b32 s42, 0xffff0000
    v_mov_b32 v132, 0xc0135761
    v_mov_b32 v133, 0xc0135761
    v_mov_b32 v134, 0xbdd2d3e8
    v_mov_b32 v135, 0xbdd2d3e8
    v_mov_b32 v136, 1.0
    v_mov_b32 v137, 1.0
    v_cvt_pk_bf16_f32 v20, 0, v20
    v_cvt_pk_bf16_f32 v22, 0, v22
    v_cvt_pk_bf16_f32 v21, 0, v21
    v_cvt_pk_bf16_f32 v23, 0, v23
    v_cvt_pk_bf16_f32 v28, 0, v28
    v_cvt_pk_bf16_f32 v30, 0, v30
    v_cvt_pk_bf16_f32 v29, 0, v29
    v_cvt_pk_bf16_f32 v31, 0, v31
    v_pk_mul_f32 v[84:85], v[20:21], v[20:21]
    v_pk_mul_f32 v[92:93], v[22:23], v[22:23]
    v_pk_fma_f32 v[84:85], v[84:85], v[134:135], v[132:133]
    v_pk_fma_f32 v[92:93], v[92:93], v[134:135], v[132:133]
    v_pk_mul_f32 v[84:85], v[84:85], v[20:21]
    v_pk_mul_f32 v[92:93], v[92:93], v[22:23]
    v_exp_f32 v84, v84
    v_exp_f32 v92, v92
    v_exp_f32 v85, v85
    v_exp_f32 v93, v93
    v_pk_add_f32 v[84:85], v[84:85], v[136:137]
    v_pk_add_f32 v[92:93], v[92:93], v[136:137]
    v_rcp_f32 v84, v84
    v_rcp_f32 v92, v92
    v_rcp_f32 v85, v85
    v_rcp_f32 v93, v93
    v_pk_mul_f32 v[84:85], v[84:85], v[20:21]
    v_pk_mul_f32 v[92:93], v[92:93], v[22:23]
    v_cvt_pk_bf16_f32 v86, 0, v84
    v_cvt_pk_bf16_f32 v94, 0, v92
    v_cvt_pk_bf16_f32 v87, 0, v85
    v_cvt_pk_bf16_f32 v95, 0, v93
    v_pk_mul_f32 v[86:87], v[86:87], v[28:29]
    v_pk_mul_f32 v[94:95], v[94:95], v[30:31]
    v_cvt_pk_bf16_f32 v116, v86, v87
    v_cvt_pk_bf16_f32 v117, v94, v95
    v_cvt_pk_bf16_f32 v24, 0, v24
    v_cvt_pk_bf16_f32 v26, 0, v26
    v_cvt_pk_bf16_f32 v25, 0, v25
    v_cvt_pk_bf16_f32 v27, 0, v27
    v_cvt_pk_bf16_f32 v32, 0, v32
    v_cvt_pk_bf16_f32 v34, 0, v34
    v_cvt_pk_bf16_f32 v33, 0, v33
    v_cvt_pk_bf16_f32 v35, 0, v35
    v_pk_mul_f32 v[100:101], v[24:25], v[24:25]
    v_pk_mul_f32 v[108:109], v[26:27], v[26:27]
    v_pk_fma_f32 v[100:101], v[100:101], v[134:135], v[132:133]
    v_pk_fma_f32 v[108:109], v[108:109], v[134:135], v[132:133]
    v_pk_mul_f32 v[100:101], v[100:101], v[24:25]
    v_pk_mul_f32 v[108:109], v[108:109], v[26:27]
    v_exp_f32 v100, v100
    v_exp_f32 v108, v108
    v_exp_f32 v101, v101
    v_exp_f32 v109, v109
    v_pk_add_f32 v[100:101], v[100:101], v[136:137]
    v_pk_add_f32 v[108:109], v[108:109], v[136:137]
    v_rcp_f32 v100, v100
    v_rcp_f32 v108, v108
    v_rcp_f32 v101, v101
    v_rcp_f32 v109, v109
    v_pk_mul_f32 v[100:101], v[100:101], v[24:25]
    v_pk_mul_f32 v[108:109], v[108:109], v[26:27]
    v_cvt_pk_bf16_f32 v102, 0, v100
    v_cvt_pk_bf16_f32 v110, 0, v108
    v_cvt_pk_bf16_f32 v103, 0, v101
    v_cvt_pk_bf16_f32 v111, 0, v109
    v_pk_mul_f32 v[102:103], v[102:103], v[32:33]
    v_pk_mul_f32 v[110:111], v[110:111], v[34:35]
    v_cvt_pk_bf16_f32 v118, v102, v103
    v_cvt_pk_bf16_f32 v119, v110, v111
    s_nop 0
    v_permlane16_swap_b32 v116, v118
    v_permlane16_swap_b32 v117, v119
    buffer_store_dwordx4 v[116:119], v15, s[24:27], s39 offen
    v_cvt_pk_bf16_f32 v36, 0, v36
    v_cvt_pk_bf16_f32 v38, 0, v38
    v_cvt_pk_bf16_f32 v37, 0, v37
    v_cvt_pk_bf16_f32 v39, 0, v39
    v_cvt_pk_bf16_f32 v44, 0, v44
    v_cvt_pk_bf16_f32 v46, 0, v46
    v_cvt_pk_bf16_f32 v45, 0, v45
    v_cvt_pk_bf16_f32 v47, 0, v47
    v_pk_mul_f32 v[84:85], v[36:37], v[36:37]
    v_pk_mul_f32 v[92:93], v[38:39], v[38:39]
    v_pk_fma_f32 v[84:85], v[84:85], v[134:135], v[132:133]
    v_pk_fma_f32 v[92:93], v[92:93], v[134:135], v[132:133]
    v_pk_mul_f32 v[84:85], v[84:85], v[36:37]
    v_pk_mul_f32 v[92:93], v[92:93], v[38:39]
    v_exp_f32 v84, v84
    v_exp_f32 v92, v92
    v_exp_f32 v85, v85
    v_exp_f32 v93, v93
    v_pk_add_f32 v[84:85], v[84:85], v[136:137]
    v_pk_add_f32 v[92:93], v[92:93], v[136:137]
    v_rcp_f32 v84, v84
    v_rcp_f32 v92, v92
    v_rcp_f32 v85, v85
    v_rcp_f32 v93, v93
    v_pk_mul_f32 v[84:85], v[84:85], v[36:37]
    v_pk_mul_f32 v[92:93], v[92:93], v[38:39]
    v_cvt_pk_bf16_f32 v86, 0, v84
    v_cvt_pk_bf16_f32 v94, 0, v92
    v_cvt_pk_bf16_f32 v87, 0, v85
    v_cvt_pk_bf16_f32 v95, 0, v93
    v_pk_mul_f32 v[86:87], v[86:87], v[44:45]
    v_pk_mul_f32 v[94:95], v[94:95], v[46:47]
    v_cvt_pk_bf16_f32 v120, v86, v87
    v_cvt_pk_bf16_f32 v121, v94, v95
    v_cvt_pk_bf16_f32 v40, 0, v40
    v_cvt_pk_bf16_f32 v42, 0, v42
    v_cvt_pk_bf16_f32 v41, 0, v41
    v_cvt_pk_bf16_f32 v43, 0, v43
    v_cvt_pk_bf16_f32 v48, 0, v48
    v_cvt_pk_bf16_f32 v50, 0, v50
    v_cvt_pk_bf16_f32 v49, 0, v49
    v_cvt_pk_bf16_f32 v51, 0, v51
    v_pk_mul_f32 v[100:101], v[40:41], v[40:41]
    v_pk_mul_f32 v[108:109], v[42:43], v[42:43]
    v_pk_fma_f32 v[100:101], v[100:101], v[134:135], v[132:133]
    v_pk_fma_f32 v[108:109], v[108:109], v[134:135], v[132:133]
    v_pk_mul_f32 v[100:101], v[100:101], v[40:41]
    v_pk_mul_f32 v[108:109], v[108:109], v[42:43]
    v_exp_f32 v100, v100
    v_exp_f32 v108, v108
    v_exp_f32 v101, v101
    v_exp_f32 v109, v109
    v_pk_add_f32 v[100:101], v[100:101], v[136:137]
    v_pk_add_f32 v[108:109], v[108:109], v[136:137]
    v_rcp_f32 v100, v100
    v_rcp_f32 v108, v108
    v_rcp_f32 v101, v101
    v_rcp_f32 v109, v109
    v_pk_mul_f32 v[100:101], v[100:101], v[40:41]
    v_pk_mul_f32 v[108:109], v[108:109], v[42:43]
    v_cvt_pk_bf16_f32 v102, 0, v100
    v_cvt_pk_bf16_f32 v110, 0, v108
    v_cvt_pk_bf16_f32 v103, 0, v101
    v_cvt_pk_bf16_f32 v111, 0, v109
    v_pk_mul_f32 v[102:103], v[102:103], v[48:49]
    v_pk_mul_f32 v[110:111], v[110:111], v[50:51]
    v_cvt_pk_bf16_f32 v122, v102, v103
    v_cvt_pk_bf16_f32 v123, v110, v111
    s_nop 0
    v_permlane16_swap_b32 v120, v122
    v_permlane16_swap_b32 v121, v123
    s_add_u32 s39, s39, 55296
    buffer_store_dwordx4 v[120:123], v15, s[24:27], s39 offen
    v_cvt_pk_bf16_f32 v52, 0, v52
    v_cvt_pk_bf16_f32 v54, 0, v54
    v_cvt_pk_bf16_f32 v53, 0, v53
    v_cvt_pk_bf16_f32 v55, 0, v55
    v_cvt_pk_bf16_f32 v60, 0, v60
    v_cvt_pk_bf16_f32 v62, 0, v62
    v_cvt_pk_bf16_f32 v61, 0, v61
    v_cvt_pk_bf16_f32 v63, 0, v63
    v_pk_mul_f32 v[84:85], v[52:53], v[52:53]
    v_pk_mul_f32 v[92:93], v[54:55], v[54:55]
    v_pk_fma_f32 v[84:85], v[84:85], v[134:135], v[132:133]
    v_pk_fma_f32 v[92:93], v[92:93], v[134:135], v[132:133]
    v_pk_mul_f32 v[84:85], v[84:85], v[52:53]
    v_pk_mul_f32 v[92:93], v[92:93], v[54:55]
    v_exp_f32 v84, v84
    v_exp_f32 v92, v92
    v_exp_f32 v85, v85
    v_exp_f32 v93, v93
    v_pk_add_f32 v[84:85], v[84:85], v[136:137]
    v_pk_add_f32 v[92:93], v[92:93], v[136:137]
    v_rcp_f32 v84, v84
    v_rcp_f32 v92, v92
    v_rcp_f32 v85, v85
    v_rcp_f32 v93, v93
    v_pk_mul_f32 v[84:85], v[84:85], v[52:53]
    v_pk_mul_f32 v[92:93], v[92:93], v[54:55]
    v_cvt_pk_bf16_f32 v86, 0, v84
    v_cvt_pk_bf16_f32 v94, 0, v92
    v_cvt_pk_bf16_f32 v87, 0, v85
    v_cvt_pk_bf16_f32 v95, 0, v93
    v_pk_mul_f32 v[86:87], v[86:87], v[60:61]
    v_pk_mul_f32 v[94:95], v[94:95], v[62:63]
    v_cvt_pk_bf16_f32 v124, v86, v87
    v_cvt_pk_bf16_f32 v125, v94, v95
    v_cvt_pk_bf16_f32 v56, 0, v56
    v_cvt_pk_bf16_f32 v58, 0, v58
    v_cvt_pk_bf16_f32 v57, 0, v57
    v_cvt_pk_bf16_f32 v59, 0, v59
    v_cvt_pk_bf16_f32 v64, 0, v64
    v_cvt_pk_bf16_f32 v66, 0, v66
    v_cvt_pk_bf16_f32 v65, 0, v65
    v_cvt_pk_bf16_f32 v67, 0, v67
    v_pk_mul_f32 v[100:101], v[56:57], v[56:57]
    v_pk_mul_f32 v[108:109], v[58:59], v[58:59]
    v_pk_fma_f32 v[100:101], v[100:101], v[134:135], v[132:133]
    v_pk_fma_f32 v[108:109], v[108:109], v[134:135], v[132:133]
    v_pk_mul_f32 v[100:101], v[100:101], v[56:57]
    v_pk_mul_f32 v[108:109], v[108:109], v[58:59]
    v_exp_f32 v100, v100
    v_exp_f32 v108, v108
    v_exp_f32 v101, v101
    v_exp_f32 v109, v109
    v_pk_add_f32 v[100:101], v[100:101], v[136:137]
    v_pk_add_f32 v[108:109], v[108:109], v[136:137]
    v_rcp_f32 v100, v100
    v_rcp_f32 v108, v108
    v_rcp_f32 v101, v101
    v_rcp_f32 v109, v109
    v_pk_mul_f32 v[100:101], v[100:101], v[56:57]
    v_pk_mul_f32 v[108:109], v[108:109], v[58:59]
    v_cvt_pk_bf16_f32 v102, 0, v100
    v_cvt_pk_bf16_f32 v110, 0, v108
    v_cvt_pk_bf16_f32 v103, 0, v101
    v_cvt_pk_bf16_f32 v111, 0, v109
    v_pk_mul_f32 v[102:103], v[102:103], v[64:65]
    v_pk_mul_f32 v[110:111], v[110:111], v[66:67]
    v_cvt_pk_bf16_f32 v126, v102, v103
    v_cvt_pk_bf16_f32 v127, v110, v111
    s_nop 0
    v_permlane16_swap_b32 v124, v126
    v_permlane16_swap_b32 v125, v127
    s_add_u32 s39, s39, 55296
    buffer_store_dwordx4 v[124:127], v15, s[24:27], s39 offen
    v_cvt_pk_bf16_f32 v68, 0, v68
    v_cvt_pk_bf16_f32 v70, 0, v70
    v_cvt_pk_bf16_f32 v69, 0, v69
    v_cvt_pk_bf16_f32 v71, 0, v71
    v_cvt_pk_bf16_f32 v76, 0, v76
    v_cvt_pk_bf16_f32 v78, 0, v78
    v_cvt_pk_bf16_f32 v77, 0, v77
    v_cvt_pk_bf16_f32 v79, 0, v79
    v_pk_mul_f32 v[84:85], v[68:69], v[68:69]
    v_pk_mul_f32 v[92:93], v[70:71], v[70:71]
    v_pk_fma_f32 v[84:85], v[84:85], v[134:135], v[132:133]
    v_pk_fma_f32 v[92:93], v[92:93], v[134:135], v[132:133]
    v_pk_mul_f32 v[84:85], v[84:85], v[68:69]
    v_pk_mul_f32 v[92:93], v[92:93], v[70:71]
    v_exp_f32 v84, v84
    v_exp_f32 v92, v92
    v_exp_f32 v85, v85
    v_exp_f32 v93, v93
    v_pk_add_f32 v[84:85], v[84:85], v[136:137]
    v_pk_add_f32 v[92:93], v[92:93], v[136:137]
    v_rcp_f32 v84, v84
    v_rcp_f32 v92, v92
    v_rcp_f32 v85, v85
    v_rcp_f32 v93, v93
    v_pk_mul_f32 v[84:85], v[84:85], v[68:69]
    v_pk_mul_f32 v[92:93], v[92:93], v[70:71]
    v_cvt_pk_bf16_f32 v86, 0, v84
    v_cvt_pk_bf16_f32 v94, 0, v92
    v_cvt_pk_bf16_f32 v87, 0, v85
    v_cvt_pk_bf16_f32 v95, 0, v93
    v_pk_mul_f32 v[86:87], v[86:87], v[76:77]
    v_pk_mul_f32 v[94:95], v[94:95], v[78:79]
    v_cvt_pk_bf16_f32 v128, v86, v87
    v_cvt_pk_bf16_f32 v129, v94, v95
    v_cvt_pk_bf16_f32 v72, 0, v72
    v_cvt_pk_bf16_f32 v74, 0, v74
    v_cvt_pk_bf16_f32 v73, 0, v73
    v_cvt_pk_bf16_f32 v75, 0, v75
    v_cvt_pk_bf16_f32 v80, 0, v80
    v_cvt_pk_bf16_f32 v82, 0, v82
    v_cvt_pk_bf16_f32 v81, 0, v81
    v_cvt_pk_bf16_f32 v83, 0, v83
    v_pk_mul_f32 v[100:101], v[72:73], v[72:73]
    v_pk_mul_f32 v[108:109], v[74:75], v[74:75]
    v_pk_fma_f32 v[100:101], v[100:101], v[134:135], v[132:133]
    v_pk_fma_f32 v[108:109], v[108:109], v[134:135], v[132:133]
    v_pk_mul_f32 v[100:101], v[100:101], v[72:73]
    v_pk_mul_f32 v[108:109], v[108:109], v[74:75]
    v_exp_f32 v100, v100
    v_exp_f32 v108, v108
    v_exp_f32 v101, v101
    v_exp_f32 v109, v109
    v_pk_add_f32 v[100:101], v[100:101], v[136:137]
    v_pk_add_f32 v[108:109], v[108:109], v[136:137]
    v_rcp_f32 v100, v100
    v_rcp_f32 v108, v108
    v_rcp_f32 v101, v101
    v_rcp_f32 v109, v109
    v_pk_mul_f32 v[100:101], v[100:101], v[72:73]
    v_pk_mul_f32 v[108:109], v[108:109], v[74:75]
    v_cvt_pk_bf16_f32 v102, 0, v100
    v_cvt_pk_bf16_f32 v110, 0, v108
    v_cvt_pk_bf16_f32 v103, 0, v101
    v_cvt_pk_bf16_f32 v111, 0, v109
    v_pk_mul_f32 v[102:103], v[102:103], v[80:81]
    v_pk_mul_f32 v[110:111], v[110:111], v[82:83]
    v_cvt_pk_bf16_f32 v130, v102, v103
    v_cvt_pk_bf16_f32 v131, v110, v111
    s_nop 0
    v_permlane16_swap_b32 v128, v130
    v_permlane16_swap_b32 v129, v131
    s_add_u32 s39, s39, 55296
    buffer_store_dwordx4 v[128:131], v15, s[24:27], s39 offen
    s_endpgm
k4_prod:
    s_setprio 3
    v_lshrrev_b32 v2, 3, v1
    v_and_b32 v3, 7, v1
    v_xor_b32 v4, v3, v2
    v_lshlrev_b32 v4, 4, v4
    v_mul_u32_u24 v5, 1280, v2
    v_add_u32 v8, v4, v5
    v_mul_u32_u24 v5, 3456, v2
    v_and_b32 v4, 2, v2
    v_xor_b32 v4, v3, v4
    v_lshl_add_u32 v7, v4, 4, v5
    v_xor_b32 v15, 64, v7
    s_waitcnt lgkmcnt(0)
    s_mov_b32 s12, s4
    s_mov_b32 s13, s5
    s_mov_b32 s14, 0x21c000
    s_mov_b32 s15, 0x00020000
    s_mov_b32 s16, s6
    s_mov_b32 s17, s7
    s_mov_b32 s18, 0x21c000
    s_mov_b32 s19, 0x00020000
    s_add_u32 s20, s8, 0xc00000
    s_addc_u32 s21, s9, 0
    s_mov_b32 s22, 0x280000
    s_mov_b32 s23, 0x00020000
    s_cmp_eq_u32 s28, 9
    s_cbranch_scc1 k4_p1
    v_add_u32 v20, 0, v7
    v_add_u32 v21, 0, v7
    v_add_u32 v22, 27648, v15
    v_add_u32 v23, 27648, v15
    v_add_u32 v24, 55296, v7
    v_add_u32 v25, 55296, v7
    v_add_u32 v26, 82944, v15
    v_add_u32 v27, 82944, v15
    v_add_u32 v28, 110592, v7
    v_add_u32 v29, 110592, v7
    v_add_u32 v30, 138240, v15
    v_add_u32 v31, 138240, v15
    v_add_u32 v32, 165888, v7
    v_add_u32 v33, 165888, v7
    v_add_u32 v34, 193536, v15
    v_add_u32 v35, 193536, v15
    v_add_u32 v36, 0, v8
    v_add_u32 v37, 10240, v8
    v_add_u32 v38, 20480, v8
    v_add_u32 v39, 30720, v8
    v_add_u32 v40, 40960, v8
    v_add_u32 v41, 51200, v8
    v_add_u32 v42, 61440, v8
    v_add_u32 v43, 71680, v8
    s_mov_b32 m0, 0
    s_nop 0
    buffer_load_dwordx4 v20, s[12:15], s29 offen lds
    s_mov_b32 m0, 8192
    s_nop 0
    buffer_load_dwordx4 v21, s[16:19], s29 offen lds
    s_mov_b32 m0, 1024
    s_nop 0
    buffer_load_dwordx4 v22, s[12:15], s29 offen lds
    s_mov_b32 m0, 9216
    s_nop 0
    buffer_load_dwordx4 v23, s[16:19], s29 offen lds
    s_mov_b32 m0, 2048
    s_nop 0
    buffer_load_dwordx4 v24, s[12:15], s29 offen lds
    s_mov_b32 m0, 10240
    s_nop 0
    buffer_load_dwordx4 v25, s[16:19], s29 offen lds
    s_mov_b32 m0, 3072
    s_nop 0
    buffer_load_dwordx4 v26, s[12:15], s29 offen lds
    s_mov_b32 m0, 11264
    s_nop 0
    buffer_load_dwordx4 v27, s[16:19], s29 offen lds
    s_mov_b32 m0, 4096
    s_nop 0
    buffer_load_dwordx4 v28, s[12:15], s29 offen lds
    s_mov_b32 m0, 12288
    s_nop 0
    buffer_load_dwordx4 v29, s[16:19], s29 offen lds
    s_mov_b32 m0, 5120
    s_nop 0
    buffer_load_dwordx4 v30, s[12:15], s29 offen lds
    s_mov_b32 m0, 13312
    s_nop 0
    buffer_load_dwordx4 v31, s[16:19], s29 offen lds
    s_mov_b32 m0, 6144
    s_nop 0
    buffer_load_dwordx4 v32, s[12:15], s29 offen lds
    s_mov_b32 m0, 14336
    s_nop 0
    buffer_load_dwordx4 v33, s[16:19], s29 offen lds
    s_mov_b32 m0, 7168
    s_nop 0
    buffer_load_dwordx4 v34, s[12:15], s29 offen lds
    s_mov_b32 m0, 15360
    s_nop 0
    buffer_load_dwordx4 v35, s[16:19], s29 offen lds
    s_mov_b32 m0, 16384
    s_nop 0
    buffer_load_dwordx4 v36, s[20:23], s30 offen lds
    s_mov_b32 m0, 17408
    s_nop 0
    buffer_load_dwordx4 v37, s[20:23], s30 offen lds
    s_mov_b32 m0, 18432
    s_nop 0
    buffer_load_dwordx4 v38, s[20:23], s30 offen lds
    s_mov_b32 m0, 19456
    s_nop 0
    buffer_load_dwordx4 v39, s[20:23], s30 offen lds
    s_mov_b32 m0, 20480
    s_nop 0
    buffer_load_dwordx4 v40, s[20:23], s30 offen lds
    s_mov_b32 m0, 21504
    s_nop 0
    buffer_load_dwordx4 v41, s[20:23], s30 offen lds
    s_mov_b32 m0, 22528
    s_nop 0
    buffer_load_dwordx4 v42, s[20:23], s30 offen lds
    s_mov_b32 m0, 23552
    s_nop 0
    buffer_load_dwordx4 v43, s[20:23], s30 offen lds
    s_add_u32 s29, s29, 221184
    s_add_u32 s30, s30, 128
    s_add_u32 s44, s44, 1
    s_cmp_eq_u32 s44, 10
    s_cselect_b32 s44, 0, s44
    s_cselect_b32 s47, 2211840, 0
    s_cselect_b32 s46, 1280, 0
    s_sub_u32 s29, s29, s47
    s_sub_u32 s30, s30, s46
    s_mov_b32 m0, 49152
    s_nop 0
    buffer_load_dwordx4 v20, s[12:15], s29 offen lds
    s_mov_b32 m0, 57344
    s_nop 0
    buffer_load_dwordx4 v21, s[16:19], s29 offen lds
    s_mov_b32 m0, 50176
    s_nop 0
    buffer_load_dwordx4 v22, s[12:15], s29 offen lds
    s_mov_b32 m0, 58368
    s_nop 0
    buffer_load_dwordx4 v23, s[16:19], s29 offen lds
    s_mov_b32 m0, 51200
    s_nop 0
    buffer_load_dwordx4 v24, s[12:15], s29 offen lds
    s_mov_b32 m0, 59392
    s_nop 0
    buffer_load_dwordx4 v25, s[16:19], s29 offen lds
    s_mov_b32 m0, 52224
    s_nop 0
    buffer_load_dwordx4 v26, s[12:15], s29 offen lds
    s_mov_b32 m0, 60416
    s_nop 0
    buffer_load_dwordx4 v27, s[16:19], s29 offen lds
    s_mov_b32 m0, 53248
    s_nop 0
    buffer_load_dwordx4 v28, s[12:15], s29 offen lds
    s_mov_b32 m0, 61440
    s_nop 0
    buffer_load_dwordx4 v29, s[16:19], s29 offen lds
    s_mov_b32 m0, 54272
    s_nop 0
    buffer_load_dwordx4 v30, s[12:15], s29 offen lds
    s_mov_b32 m0, 62464
    s_nop 0
    buffer_load_dwordx4 v31, s[16:19], s29 offen lds
    s_mov_b32 m0, 55296
    s_nop 0
    buffer_load_dwordx4 v32, s[12:15], s29 offen lds
    s_mov_b32 m0, 63488
    s_nop 0
    buffer_load_dwordx4 v33, s[16:19], s29 offen lds
    s_mov_b32 m0, 56320
    s_nop 0
    buffer_load_dwordx4 v34, s[12:15], s29 offen lds
    s_mov_b32 m0, 64512
    s_nop 0
    buffer_load_dwordx4 v35, s[16:19], s29 offen lds
    s_mov_b32 m0, 65536
    s_nop 0
    buffer_load_dwordx4 v36, s[20:23], s30 offen lds
    s_mov_b32 m0, 66560
    s_nop 0
    buffer_load_dwordx4 v37, s[20:23], s30 offen lds
    s_mov_b32 m0, 67584
    s_nop 0
    buffer_load_dwordx4 v38, s[20:23], s30 offen lds
    s_mov_b32 m0, 68608
    s_nop 0
    buffer_load_dwordx4 v39, s[20:23], s30 offen lds
    s_mov_b32 m0, 69632
    s_nop 0
    buffer_load_dwordx4 v40, s[20:23], s30 offen lds
    s_mov_b32 m0, 70656
    s_nop 0
    buffer_load_dwordx4 v41, s[20:23], s30 offen lds
    s_mov_b32 m0, 71680
    s_nop 0
    buffer_load_dwordx4 v42, s[20:23], s30 offen lds
    s_mov_b32 m0, 72704
    s_nop 0
    buffer_load_dwordx4 v43, s[20:23], s30 offen lds
    s_add_u32 s29, s29, 221184
    s_add_u32 s30, s30, 128
    s_add_u32 s44, s44, 1
    s_cmp_eq_u32 s44, 10
    s_cselect_b32 s44, 0, s44
    s_cselect_b32 s47, 2211840, 0
    s_cselect_b32 s46, 1280, 0
    s_sub_u32 s29, s29, s47
    s_sub_u32 s30, s30, s46
    s_waitcnt vmcnt(24) lgkmcnt(0)
    s_barrier
    s_mov_b32 m0, 98304
    s_nop 0
    buffer_load_dwordx4 v20, s[12:15], s29 offen lds
    s_mov_b32 m0, 106496
    s_nop 0
    buffer_load_dwordx4 v21, s[16:19], s29 offen lds
    s_mov_b32 m0, 99328
    s_nop 0
    buffer_load_dwordx4 v22, s[12:15], s29 offen lds
    s_mov_b32 m0, 107520
    s_nop 0
    buffer_load_dwordx4 v23, s[16:19], s29 offen lds
    s_mov_b32 m0, 100352
    s_nop 0
    buffer_load_dwordx4 v24, s[12:15], s29 offen lds
    s_mov_b32 m0, 108544
    s_nop 0
    buffer_load_dwordx4 v25, s[16:19], s29 offen lds
    s_mov_b32 m0, 101376
    s_nop 0
    buffer_load_dwordx4 v26, s[12:15], s29 offen lds
    s_mov_b32 m0, 109568
    s_nop 0
    buffer_load_dwordx4 v27, s[16:19], s29 offen lds
    s_mov_b32 m0, 102400
    s_nop 0
    buffer_load_dwordx4 v28, s[12:15], s29 offen lds
    s_mov_b32 m0, 110592
    s_nop 0
    buffer_load_dwordx4 v29, s[16:19], s29 offen lds
    s_mov_b32 m0, 103424
    s_nop 0
    buffer_load_dwordx4 v30, s[12:15], s29 offen lds
    s_mov_b32 m0, 111616
    s_nop 0
    buffer_load_dwordx4 v31, s[16:19], s29 offen lds
    s_mov_b32 m0, 104448
    s_nop 0
    buffer_load_dwordx4 v32, s[12:15], s29 offen lds
    s_mov_b32 m0, 112640
    s_nop 0
    buffer_load_dwordx4 v33, s[16:19], s29 offen lds
    s_mov_b32 m0, 105472
    s_nop 0
    buffer_load_dwordx4 v34, s[12:15], s29 offen lds
    s_mov_b32 m0, 113664
    s_nop 0
    buffer_load_dwordx4 v35, s[16:19], s29 offen lds
    s_mov_b32 m0, 114688
    s_nop 0
    buffer_load_dwordx4 v36, s[20:23], s30 offen lds
    s_mov_b32 m0, 115712
    s_nop 0
    buffer_load_dwordx4 v37, s[20:23], s30 offen lds
    s_mov_b32 m0, 116736
    s_nop 0
    buffer_load_dwordx4 v38, s[20:23], s30 offen lds
    s_mov_b32 m0, 117760
    s_nop 0
    buffer_load_dwordx4 v39, s[20:23], s30 offen lds
    s_mov_b32 m0, 118784
    s_nop 0
    buffer_load_dwordx4 v40, s[20:23], s30 offen lds
    s_mov_b32 m0, 119808
    s_nop 0
    buffer_load_dwordx4 v41, s[20:23], s30 offen lds
    s_mov_b32 m0, 120832
    s_nop 0
    buffer_load_dwordx4 v42, s[20:23], s30 offen lds
    s_mov_b32 m0, 121856
    s_nop 0
    buffer_load_dwordx4 v43, s[20:23], s30 offen lds
    s_add_u32 s29, s29, 221184
    s_add_u32 s30, s30, 128
    s_add_u32 s44, s44, 1
    s_cmp_eq_u32 s44, 10
    s_cselect_b32 s44, 0, s44
    s_cselect_b32 s47, 2211840, 0
    s_cselect_b32 s46, 1280, 0
    s_sub_u32 s29, s29, s47
    s_sub_u32 s30, s30, s46
    s_mov_b32 s36, 0
    s_mov_b32 s35, 0
k4_l0:
    s_waitcnt vmcnt(24)
    s_barrier
    s_add_u32 m0, s36, 0
    s_nop 0
    buffer_load_dwordx4 v20, s[12:15], s29 offen lds
    s_add_u32 m0, s36, 8192
    s_nop 0
    buffer_load_dwordx4 v21, s[16:19], s29 offen lds
    s_add_u32 m0, s36, 1024
    s_nop 0
    buffer_load_dwordx4 v22, s[12:15], s29 offen lds
    s_add_u32 m0, s36, 9216
    s_nop 0
    buffer_load_dwordx4 v23, s[16:19], s29 offen lds
    s_add_u32 m0, s36, 2048
    s_nop 0
    buffer_load_dwordx4 v24, s[12:15], s29 offen lds
    s_add_u32 m0, s36, 10240
    s_nop 0
    buffer_load_dwordx4 v25, s[16:19], s29 offen lds
    s_add_u32 m0, s36, 3072
    s_nop 0
    buffer_load_dwordx4 v26, s[12:15], s29 offen lds
    s_add_u32 m0, s36, 11264
    s_nop 0
    buffer_load_dwordx4 v27, s[16:19], s29 offen lds
    s_add_u32 m0, s36, 4096
    s_nop 0
    buffer_load_dwordx4 v28, s[12:15], s29 offen lds
    s_add_u32 m0, s36, 12288
    s_nop 0
    buffer_load_dwordx4 v29, s[16:19], s29 offen lds
    s_add_u32 m0, s36, 5120
    s_nop 0
    buffer_load_dwordx4 v30, s[12:15], s29 offen lds
    s_add_u32 m0, s36, 13312
    s_nop 0
    buffer_load_dwordx4 v31, s[16:19], s29 offen lds
    s_add_u32 m0, s36, 6144
    s_nop 0
    buffer_load_dwordx4 v32, s[12:15], s29 offen lds
    s_add_u32 m0, s36, 14336
    s_nop 0
    buffer_load_dwordx4 v33, s[16:19], s29 offen lds
    s_add_u32 m0, s36, 7168
    s_nop 0
    buffer_load_dwordx4 v34, s[12:15], s29 offen lds
    s_add_u32 m0, s36, 15360
    s_nop 0
    buffer_load_dwordx4 v35, s[16:19], s29 offen lds
    s_add_u32 m0, s36, 16384
    s_nop 0
    buffer_load_dwordx4 v36, s[20:23], s30 offen lds
    s_add_u32 m0, s36, 17408
    s_nop 0
    buffer_load_dwordx4 v37, s[20:23], s30 offen lds
    s_add_u32 m0, s36, 18432
    s_nop 0
    buffer_load_dwordx4 v38, s[20:23], s30 offen lds
    s_add_u32 m0, s36, 19456
    s_nop 0
    buffer_load_dwordx4 v39, s[20:23], s30 offen lds
    s_add_u32 m0, s36, 20480
    s_nop 0
    buffer_load_dwordx4 v40, s[20:23], s30 offen lds
    s_add_u32 m0, s36, 21504
    s_nop 0
    buffer_load_dwordx4 v41, s[20:23], s30 offen lds
    s_add_u32 m0, s36, 22528
    s_nop 0
    buffer_load_dwordx4 v42, s[20:23], s30 offen lds
    s_add_u32 m0, s36, 23552
    s_nop 0
    buffer_load_dwordx4 v43, s[20:23], s30 offen lds
    s_add_u32 s29, s29, 221184
    s_add_u32 s30, s30, 128
    s_add_u32 s44, s44, 1
    s_cmp_eq_u32 s44, 10
    s_cselect_b32 s44, 0, s44
    s_cselect_b32 s47, 2211840, 0
    s_cselect_b32 s46, 1280, 0
    s_sub_u32 s29, s29, s47
    s_sub_u32 s30, s30, s46
    s_add_u32 s36, s36, 49152
    s_cmp_eq_u32 s36, 147456
    s_cselect_b32 s36, 0, s36
    s_add_u32 s35, s35, 1
    s_cmp_lt_u32 s35, 7
    s_cbranch_scc1 k4_l0
    s_waitcnt vmcnt(24)
    s_barrier
    s_waitcnt vmcnt(0)
    s_barrier
    s_endpgm
k4_p1:
    v_add_u32 v20, 81920, v8
    v_add_u32 v21, 92160, v8
    v_add_u32 v22, 102400, v8
    v_add_u32 v23, 112640, v8
    v_add_u32 v24, 122880, v8
    v_add_u32 v25, 133120, v8
    v_add_u32 v26, 143360, v8
    v_add_u32 v27, 153600, v8
    v_add_u32 v28, 163840, v8
    v_add_u32 v29, 174080, v8
    v_add_u32 v30, 184320, v8
    v_add_u32 v31, 194560, v8
    v_add_u32 v32, 204800, v8
    v_add_u32 v33, 215040, v8
    v_add_u32 v34, 225280, v8
    v_add_u32 v35, 235520, v8
    v_add_u32 v36, 245760, v8
    v_add_u32 v37, 256000, v8
    v_add_u32 v38, 266240, v8
    v_add_u32 v39, 276480, v8
    v_add_u32 v40, 286720, v8
    v_add_u32 v41, 296960, v8
    v_add_u32 v42, 307200, v8
    v_add_u32 v43, 317440, v8
    s_mov_b32 m0, 24576
    s_nop 0
    buffer_load_dwordx4 v20, s[20:23], s30 offen lds
    s_mov_b32 m0, 25600
    s_nop 0
    buffer_load_dwordx4 v21, s[20:23], s30 offen lds
    s_mov_b32 m0, 26624
    s_nop 0
    buffer_load_dwordx4 v22, s[20:23], s30 offen lds
    s_mov_b32 m0, 27648
    s_nop 0
    buffer_load_dwordx4 v23, s[20:23], s30 offen lds
    s_mov_b32 m0, 28672
    s_nop 0
    buffer_load_dwordx4 v24, s[20:23], s30 offen lds
    s_mov_b32 m0, 29696
    s_nop 0
    buffer_load_dwordx4 v25, s[20:23], s30 offen lds
    s_mov_b32 m0, 30720
    s_nop 0
    buffer_load_dwordx4 v26, s[20:23], s30 offen lds
    s_mov_b32 m0, 31744
    s_nop 0
    buffer_load_dwordx4 v27, s[20:23], s30 offen lds
    s_mov_b32 m0, 32768
    s_nop 0
    buffer_load_dwordx4 v28, s[20:23], s30 offen lds
    s_mov_b32 m0, 33792
    s_nop 0
    buffer_load_dwordx4 v29, s[20:23], s30 offen lds
    s_mov_b32 m0, 34816
    s_nop 0
    buffer_load_dwordx4 v30, s[20:23], s30 offen lds
    s_mov_b32 m0, 35840
    s_nop 0
    buffer_load_dwordx4 v31, s[20:23], s30 offen lds
    s_mov_b32 m0, 36864
    s_nop 0
    buffer_load_dwordx4 v32, s[20:23], s30 offen lds
    s_mov_b32 m0, 37888
    s_nop 0
    buffer_load_dwordx4 v33, s[20:23], s30 offen lds
    s_mov_b32 m0, 38912
    s_nop 0
    buffer_load_dwordx4 v34, s[20:23], s30 offen lds
    s_mov_b32 m0, 39936
    s_nop 0
    buffer_load_dwordx4 v35, s[20:23], s30 offen lds
    s_mov_b32 m0, 40960
    s_nop 0
    buffer_load_dwordx4 v36, s[20:23], s30 offen lds
    s_mov_b32 m0, 41984
    s_nop 0
    buffer_load_dwordx4 v37, s[20:23], s30 offen lds
    s_mov_b32 m0, 43008
    s_nop 0
    buffer_load_dwordx4 v38, s[20:23], s30 offen lds
    s_mov_b32 m0, 44032
    s_nop 0
    buffer_load_dwordx4 v39, s[20:23], s30 offen lds
    s_mov_b32 m0, 45056
    s_nop 0
    buffer_load_dwordx4 v40, s[20:23], s30 offen lds
    s_mov_b32 m0, 46080
    s_nop 0
    buffer_load_dwordx4 v41, s[20:23], s30 offen lds
    s_mov_b32 m0, 47104
    s_nop 0
    buffer_load_dwordx4 v42, s[20:23], s30 offen lds
    s_mov_b32 m0, 48128
    s_nop 0
    buffer_load_dwordx4 v43, s[20:23], s30 offen lds
    s_add_u32 s29, s29, 221184
    s_add_u32 s30, s30, 128
    s_add_u32 s44, s44, 1
    s_cmp_eq_u32 s44, 10
    s_cselect_b32 s44, 0, s44
    s_cselect_b32 s47, 2211840, 0
    s_cselect_b32 s46, 1280, 0
    s_sub_u32 s29, s29, s47
    s_sub_u32 s30, s30, s46
    s_mov_b32 m0, 73728
    s_nop 0
    buffer_load_dwordx4 v20, s[20:23], s30 offen lds
    s_mov_b32 m0, 74752
    s_nop 0
    buffer_load_dwordx4 v21, s[20:23], s30 offen lds
    s_mov_b32 m0, 75776
    s_nop 0
    buffer_load_dwordx4 v22, s[20:23], s30 offen lds
    s_mov_b32 m0, 76800
    s_nop 0
    buffer_load_dwordx4 v23, s[20:23], s30 offen lds
    s_mov_b32 m0, 77824
    s_nop 0
    buffer_load_dwordx4 v24, s[20:23], s30 offen lds
    s_mov_b32 m0, 78848
    s_nop 0
    buffer_load_dwordx4 v25, s[20:23], s30 offen lds
    s_mov_b32 m0, 79872
    s_nop 0
    buffer_load_dwordx4 v26, s[20:23], s30 offen lds
    s_mov_b32 m0, 80896
    s_nop 0
    buffer_load_dwordx4 v27, s[20:23], s30 offen lds
    s_mov_b32 m0, 81920
    s_nop 0
    buffer_load_dwordx4 v28, s[20:23], s30 offen lds
    s_mov_b32 m0, 82944
    s_nop 0
    buffer_load_dwordx4 v29, s[20:23], s30 offen lds
    s_mov_b32 m0, 83968
    s_nop 0
    buffer_load_dwordx4 v30, s[20:23], s30 offen lds
    s_mov_b32 m0, 84992
    s_nop 0
    buffer_load_dwordx4 v31, s[20:23], s30 offen lds
    s_mov_b32 m0, 86016
    s_nop 0
    buffer_load_dwordx4 v32, s[20:23], s30 offen lds
    s_mov_b32 m0, 87040
    s_nop 0
    buffer_load_dwordx4 v33, s[20:23], s30 offen lds
    s_mov_b32 m0, 88064
    s_nop 0
    buffer_load_dwordx4 v34, s[20:23], s30 offen lds
    s_mov_b32 m0, 89088
    s_nop 0
    buffer_load_dwordx4 v35, s[20:23], s30 offen lds
    s_mov_b32 m0, 90112
    s_nop 0
    buffer_load_dwordx4 v36, s[20:23], s30 offen lds
    s_mov_b32 m0, 91136
    s_nop 0
    buffer_load_dwordx4 v37, s[20:23], s30 offen lds
    s_mov_b32 m0, 92160
    s_nop 0
    buffer_load_dwordx4 v38, s[20:23], s30 offen lds
    s_mov_b32 m0, 93184
    s_nop 0
    buffer_load_dwordx4 v39, s[20:23], s30 offen lds
    s_mov_b32 m0, 94208
    s_nop 0
    buffer_load_dwordx4 v40, s[20:23], s30 offen lds
    s_mov_b32 m0, 95232
    s_nop 0
    buffer_load_dwordx4 v41, s[20:23], s30 offen lds
    s_mov_b32 m0, 96256
    s_nop 0
    buffer_load_dwordx4 v42, s[20:23], s30 offen lds
    s_mov_b32 m0, 97280
    s_nop 0
    buffer_load_dwordx4 v43, s[20:23], s30 offen lds
    s_add_u32 s29, s29, 221184
    s_add_u32 s30, s30, 128
    s_add_u32 s44, s44, 1
    s_cmp_eq_u32 s44, 10
    s_cselect_b32 s44, 0, s44
    s_cselect_b32 s47, 2211840, 0
    s_cselect_b32 s46, 1280, 0
    s_sub_u32 s29, s29, s47
    s_sub_u32 s30, s30, s46
    s_waitcnt vmcnt(24) lgkmcnt(0)
    s_barrier
    s_mov_b32 m0, 122880
    s_nop 0
    buffer_load_dwordx4 v20, s[20:23], s30 offen lds
    s_mov_b32 m0, 123904
    s_nop 0
    buffer_load_dwordx4 v21, s[20:23], s30 offen lds
    s_mov_b32 m0, 124928
    s_nop 0
    buffer_load_dwordx4 v22, s[20:23], s30 offen lds
    s_mov_b32 m0, 125952
    s_nop 0
    buffer_load_dwordx4 v23, s[20:23], s30 offen lds
    s_mov_b32 m0, 126976
    s_nop 0
    buffer_load_dwordx4 v24, s[20:23], s30 offen lds
    s_mov_b32 m0, 128000
    s_nop 0
    buffer_load_dwordx4 v25, s[20:23], s30 offen lds
    s_mov_b32 m0, 129024
    s_nop 0
    buffer_load_dwordx4 v26, s[20:23], s30 offen lds
    s_mov_b32 m0, 130048
    s_nop 0
    buffer_load_dwordx4 v27, s[20:23], s30 offen lds
    s_mov_b32 m0, 131072
    s_nop 0
    buffer_load_dwordx4 v28, s[20:23], s30 offen lds
    s_mov_b32 m0, 132096
    s_nop 0
    buffer_load_dwordx4 v29, s[20:23], s30 offen lds
    s_mov_b32 m0, 133120
    s_nop 0
    buffer_load_dwordx4 v30, s[20:23], s30 offen lds
    s_mov_b32 m0, 134144
    s_nop 0
    buffer_load_dwordx4 v31, s[20:23], s30 offen lds
    s_mov_b32 m0, 135168
    s_nop 0
    buffer_load_dwordx4 v32, s[20:23], s30 offen lds
    s_mov_b32 m0, 136192
    s_nop 0
    buffer_load_dwordx4 v33, s[20:23], s30 offen lds
    s_mov_b32 m0, 137216
    s_nop 0
    buffer_load_dwordx4 v34, s[20:23], s30 offen lds
    s_mov_b32 m0, 138240
    s_nop 0
    buffer_load_dwordx4 v35, s[20:23], s30 offen lds
    s_mov_b32 m0, 139264
    s_nop 0
    buffer_load_dwordx4 v36, s[20:23], s30 offen lds
    s_mov_b32 m0, 140288
    s_nop 0
    buffer_load_dwordx4 v37, s[20:23], s30 offen lds
    s_mov_b32 m0, 141312
    s_nop 0
    buffer_load_dwordx4 v38, s[20:23], s30 offen lds
    s_mov_b32 m0, 142336
    s_nop 0
    buffer_load_dwordx4 v39, s[20:23], s30 offen lds
    s_mov_b32 m0, 143360
    s_nop 0
    buffer_load_dwordx4 v40, s[20:23], s30 offen lds
    s_mov_b32 m0, 144384
    s_nop 0
    buffer_load_dwordx4 v41, s[20:23], s30 offen lds
    s_mov_b32 m0, 145408
    s_nop 0
    buffer_load_dwordx4 v42, s[20:23], s30 offen lds
    s_mov_b32 m0, 146432
    s_nop 0
    buffer_load_dwordx4 v43, s[20:23], s30 offen lds
    s_add_u32 s29, s29, 221184
    s_add_u32 s30, s30, 128
    s_add_u32 s44, s44, 1
    s_cmp_eq_u32 s44, 10
    s_cselect_b32 s44, 0, s44
    s_cselect_b32 s47, 2211840, 0
    s_cselect_b32 s46, 1280, 0
    s_sub_u32 s29, s29, s47
    s_sub_u32 s30, s30, s46
    s_mov_b32 s36, 0
    s_mov_b32 s35, 0
k4_l1:
    s_waitcnt vmcnt(24)
    s_barrier
    s_add_u32 m0, s36, 24576
    s_nop 0
    buffer_load_dwordx4 v20, s[20:23], s30 offen lds
    s_add_u32 m0, s36, 25600
    s_nop 0
    buffer_load_dwordx4 v21, s[20:23], s30 offen lds
    s_add_u32 m0, s36, 26624
    s_nop 0
    buffer_load_dwordx4 v22, s[20:23], s30 offen lds
    s_add_u32 m0, s36, 27648
    s_nop 0
    buffer_load_dwordx4 v23, s[20:23], s30 offen lds
    s_add_u32 m0, s36, 28672
    s_nop 0
    buffer_load_dwordx4 v24, s[20:23], s30 offen lds
    s_add_u32 m0, s36, 29696
    s_nop 0
    buffer_load_dwordx4 v25, s[20:23], s30 offen lds
    s_add_u32 m0, s36, 30720
    s_nop 0
    buffer_load_dwordx4 v26, s[20:23], s30 offen lds
    s_add_u32 m0, s36, 31744
    s_nop 0
    buffer_load_dwordx4 v27, s[20:23], s30 offen lds
    s_add_u32 m0, s36, 32768
    s_nop 0
    buffer_load_dwordx4 v28, s[20:23], s30 offen lds
    s_add_u32 m0, s36, 33792
    s_nop 0
    buffer_load_dwordx4 v29, s[20:23], s30 offen lds
    s_add_u32 m0, s36, 34816
    s_nop 0
    buffer_load_dwordx4 v30, s[20:23], s30 offen lds
    s_add_u32 m0, s36, 35840
    s_nop 0
    buffer_load_dwordx4 v31, s[20:23], s30 offen lds
    s_add_u32 m0, s36, 36864
    s_nop 0
    buffer_load_dwordx4 v32, s[20:23], s30 offen lds
    s_add_u32 m0, s36, 37888
    s_nop 0
    buffer_load_dwordx4 v33, s[20:23], s30 offen lds
    s_add_u32 m0, s36, 38912
    s_nop 0
    buffer_load_dwordx4 v34, s[20:23], s30 offen lds
    s_add_u32 m0, s36, 39936
    s_nop 0
    buffer_load_dwordx4 v35, s[20:23], s30 offen lds
    s_add_u32 m0, s36, 40960
    s_nop 0
    buffer_load_dwordx4 v36, s[20:23], s30 offen lds
    s_add_u32 m0, s36, 41984
    s_nop 0
    buffer_load_dwordx4 v37, s[20:23], s30 offen lds
    s_add_u32 m0, s36, 43008
    s_nop 0
    buffer_load_dwordx4 v38, s[20:23], s30 offen lds
    s_add_u32 m0, s36, 44032
    s_nop 0
    buffer_load_dwordx4 v39, s[20:23], s30 offen lds
    s_add_u32 m0, s36, 45056
    s_nop 0
    buffer_load_dwordx4 v40, s[20:23], s30 offen lds
    s_add_u32 m0, s36, 46080
    s_nop 0
    buffer_load_dwordx4 v41, s[20:23], s30 offen lds
    s_add_u32 m0, s36, 47104
    s_nop 0
    buffer_load_dwordx4 v42, s[20:23], s30 offen lds
    s_add_u32 m0, s36, 48128
    s_nop 0
    buffer_load_dwordx4 v43, s[20:23], s30 offen lds
    s_add_u32 s29, s29, 221184
    s_add_u32 s30, s30, 128
    s_add_u32 s44, s44, 1
    s_cmp_eq_u32 s44, 10
    s_cselect_b32 s44, 0, s44
    s_cselect_b32 s47, 2211840, 0
    s_cselect_b32 s46, 1280, 0
    s_sub_u32 s29, s29, s47
    s_sub_u32 s30, s30, s46
    s_add_u32 s36, s36, 49152
    s_cmp_eq_u32 s36, 147456
    s_cselect_b32 s36, 0, s36
    s_add_u32 s35, s35, 1
    s_cmp_lt_u32 s35, 7
    s_cbranch_scc1 k4_l1
    s_waitcnt vmcnt(24)
    s_barrier
    s_waitcnt vmcnt(0)
    s_barrier
    s_endpgm
k4_pk:
    s_load_dwordx2 s[10:11], s[0:1], 48
    s_cmp_ge_u32 s2, 256
    s_cbranch_scc1 k4_end
    v_readfirstlane_b32 s41, v0
    s_cmp_ge_u32 s41, 512
    s_cbranch_scc1 k4_end
    s_sub_u32 s40, s2, 224
    s_mul_i32 s32, s40, 69120
    s_mul_i32 s33, s40, 8640
    s_mov_b32 s34, 52429
    s_mov_b32 s35, 276320
    s_movk_i32 s36, 205
    v_mov_b32 v5, 0x80000000
    s_waitcnt lgkmcnt(0)
    s_mov_b32 s12, s10
    s_mov_b32 s13, s11
    s_mov_b32 s14, 0x21c000
    s_mov_b32 s15, 0x00020000
    s_add_u32 s16, s8, 0x1a00000
    s_addc_u32 s17, s9, 0
    s_mov_b32 s18, 0x21c000
    s_mov_b32 s19, 0x00020000
    v_add_u32 v2, 0, v0
    v_lshlrev_b32 v1, 4, v2
    v_mul_u32_u24 v3, s34, v2
    v_lshrrev_b32 v3, 22, v3
    v_mul_u32_u24 v4, 80, v3
    v_sub_u32 v2, v2, v4
    v_mul_u32_u24 v4, s36, v2
    v_lshrrev_b32 v4, 11, v4
    v_mul_u32_u24 v3, 160, v3
    v_lshl_add_u32 v3, v2, 4, v3
    v_mad_u32_u24 v84, v4, s35, v3
    buffer_load_dwordx4 v[20:23], v1, s[12:15], s32 offen
    v_add_u32 v2, 512, v0
    v_lshlrev_b32 v1, 4, v2
    v_mul_u32_u24 v3, s34, v2
    v_lshrrev_b32 v3, 22, v3
    v_mul_u32_u24 v4, 80, v3
    v_sub_u32 v2, v2, v4
    v_mul_u32_u24 v4, s36, v2
    v_lshrrev_b32 v4, 11, v4
    v_mul_u32_u24 v3, 160, v3
    v_lshl_add_u32 v3, v2, 4, v3
    v_mad_u32_u24 v85, v4, s35, v3
    buffer_load_dwordx4 v[24:27], v1, s[12:15], s32 offen
    v_add_u32 v2, 1024, v0
    v_lshlrev_b32 v1, 4, v2
    v_mul_u32_u24 v3, s34, v2
    v_lshrrev_b32 v3, 22, v3
    v_mul_u32_u24 v4, 80, v3
    v_sub_u32 v2, v2, v4
    v_mul_u32_u24 v4, s36, v2
    v_lshrrev_b32 v4, 11, v4
    v_mul_u32_u24 v3, 160, v3
    v_lshl_add_u32 v3, v2, 4, v3
    v_mad_u32_u24 v86, v4, s35, v3
    buffer_load_dwordx4 v[28:31], v1, s[12:15], s32 offen
    v_add_u32 v2, 1536, v0
    v_lshlrev_b32 v1, 4, v2
    v_mul_u32_u24 v3, s34, v2
    v_lshrrev_b32 v3, 22, v3
    v_mul_u32_u24 v4, 80, v3
    v_sub_u32 v2, v2, v4
    v_mul_u32_u24 v4, s36, v2
    v_lshrrev_b32 v4, 11, v4
    v_mul_u32_u24 v3, 160, v3
    v_lshl_add_u32 v3, v2, 4, v3
    v_mad_u32_u24 v87, v4, s35, v3
    buffer_load_dwordx4 v[32:35], v1, s[12:15], s32 offen
    v_add_u32 v2, 2048, v0
    v_lshlrev_b32 v1, 4, v2
    v_mul_u32_u24 v3, s34, v2
    v_lshrrev_b32 v3, 22, v3
    v_mul_u32_u24 v4, 80, v3
    v_sub_u32 v2, v2, v4
    v_mul_u32_u24 v4, s36, v2
    v_lshrrev_b32 v4, 11, v4
    v_mul_u32_u24 v3, 160, v3
    v_lshl_add_u32 v3, v2, 4, v3
    v_mad_u32_u24 v88, v4, s35, v3
    buffer_load_dwordx4 v[36:39], v1, s[12:15], s32 offen
    v_add_u32 v2, 2560, v0
    v_lshlrev_b32 v1, 4, v2
    v_mul_u32_u24 v3, s34, v2
    v_lshrrev_b32 v3, 22, v3
    v_mul_u32_u24 v4, 80, v3
    v_sub_u32 v2, v2, v4
    v_mul_u32_u24 v4, s36, v2
    v_lshrrev_b32 v4, 11, v4
    v_mul_u32_u24 v3, 160, v3
    v_lshl_add_u32 v3, v2, 4, v3
    v_mad_u32_u24 v89, v4, s35, v3
    buffer_load_dwordx4 v[40:43], v1, s[12:15], s32 offen
    v_add_u32 v2, 3072, v0
    v_lshlrev_b32 v1, 4, v2
    v_mul_u32_u24 v3, s34, v2
    v_lshrrev_b32 v3, 22, v3
    v_mul_u32_u24 v4, 80, v3
    v_sub_u32 v2, v2, v4
    v_mul_u32_u24 v4, s36, v2
    v_lshrrev_b32 v4, 11, v4
    v_mul_u32_u24 v3, 160, v3
    v_lshl_add_u32 v3, v2, 4, v3
    v_mad_u32_u24 v90, v4, s35, v3
    buffer_load_dwordx4 v[44:47], v1, s[12:15], s32 offen
    v_add_u32 v2, 3584, v0
    v_lshlrev_b32 v1, 4, v2
    v_mul_u32_u24 v3, s34, v2
    v_lshrrev_b32 v3, 22, v3
    v_mul_u32_u24 v4, 80, v3
    v_sub_u32 v2, v2, v4
    v_mul_u32_u24 v4, s36, v2
    v_lshrrev_b32 v4, 11, v4
    v_mul_u32_u24 v3, 160, v3
    v_lshl_add_u32 v3, v2, 4, v3
    v_mad_u32_u24 v91, v4, s35, v3
    buffer_load_dwordx4 v[48:51], v1, s[12:15], s32 offen
    v_add_u32 v2, 4096, v0
    v_lshlrev_b32 v1, 4, v2
    v_mul_u32_u24 v3, s34, v2
    v_lshrrev_b32 v3, 22, v3
    v_mul_u32_u24 v4, 80, v3
    v_sub_u32 v2, v2, v4
    v_mul_u32_u24 v4, s36, v2
    v_lshrrev_b32 v4, 11, v4
    v_mul_u32_u24 v3, 160, v3
    v_lshl_add_u32 v3, v2, 4, v3
    v_mad_u32_u24 v92, v4, s35, v3
    v_cmp_gt_u32 vcc, 224, v0
    s_nop 1
    v_cndmask_b32 v1, v5, v1, vcc
    v_cndmask_b32 v92, v5, v92, vcc
    buffer_load_dwordx4 v[52:55], v1, s[12:15], s32 offen
    s_waitcnt vmcnt(8)
    buffer_store_dwordx4 v[20:23], v84, s[16:19], s33 offen
    s_waitcnt vmcnt(8)
    buffer_store_dwordx4 v[24:27], v85, s[16:19], s33 offen
    s_waitcnt vmcnt(8)
    buffer_store_dwordx4 v[28:31], v86, s[16:19], s33 offen
    s_waitcnt vmcnt(8)
    buffer_store_dwordx4 v[32:35], v87, s[16:19], s33 offen
    s_waitcnt vmcnt(8)
    buffer_store_dwordx4 v[36:39], v88, s[16:19], s33 offen
    s_waitcnt vmcnt(8)
    buffer_store_dwordx4 v[40:43], v89, s[16:19], s33 offen
    s_waitcnt vmcnt(8)
    buffer_store_dwordx4 v[44:47], v90, s[16:19], s33 offen
    s_waitcnt vmcnt(8)
    buffer_store_dwordx4 v[48:51], v91, s[16:19], s33 offen
    s_waitcnt vmcnt(8)
    buffer_store_dwordx4 v[52:55], v92, s[16:19], s33 offen
k4_end:
    s_endpgm
.globl k5_kernel
.p2align 8
.type k5_kernel,@function
k5_kernel:
    s_load_dwordx4 s[4:7], s[0:1], 48
    s_load_dwordx2 s[8:9], s[0:1], 72
    s_cmp_ge_u32 s2, 256
    s_cbranch_scc1 k5_end
    s_and_b32 s40, s2, 7
    s_lshr_b32 s41, s2, 3
    s_lshl_b32 s42, s40, 2
    s_and_b32 s43, s41, 3
    s_add_u32 s42, s42, s43
    s_lshr_b32 s43, s41, 2
    v_lshrrev_b32 v2, 6, v0
    v_and_b32 v1, 63, v0
    v_readfirstlane_b32 s28, v2
    v_lshrrev_b32 v6, 4, v1
    s_mul_i32 s30, s42, 221184
    s_mul_i32 s29, s43, 160
    s_and_b32 s45, s41, 3
    s_mul_i32 s45, s45, 1
    s_mul_i32 s44, s43, 1
    s_add_u32 s44, s44, s45
    s_mul_i32 s45, s40, 0
    s_add_u32 s44, s44, s45
    s_mov_b32 s35, s29
    s_mul_i32 s29, s43, 276480
    s_mul_i32 s45, s44, 10240
    s_add_u32 s29, s29, s45
    s_lshl_b32 s45, s44, 7
    s_add_u32 s30, s30, s45
    s_cmp_ge_u32 s28, 4
    s_cbranch_scc1 k5_prod
    s_and_b32 s45, s28, 1
    s_lshl_b32 s45, s45, 5
    s_lshr_b32 s46, s28, 1
    s_lshl_b32 s46, s46, 4
    s_add_u32 s45, s45, s46
    s_lshl_b32 s46, s42, 6
    s_add_u32 s45, s45, s46
    s_mul_i32 s39, s45, 1280
    s_add_u32 s39, s39, s35
    v_and_b32 v2, 15, v1
    v_mul_u32_u24 v7, 1280, v2
    v_lshl_add_u32 v7, v6, 3, v7
    s_waitcnt lgkmcnt(0)
    s_mov_b32 s16, s6
    s_mov_b32 s17, s7
    s_mov_b32 s18, 0x280000
    s_mov_b32 s19, 0x00020000
    s_add_u32 s24, s8, 0x900000
    s_addc_u32 s25, s9, 0
    s_mov_b32 s26, 0x280000
    s_mov_b32 s27, 0x00020000
    s_lshr_b32 s45, s28, 1
    s_and_b32 s46, s28, 1
    v_and_b32 v2, 3, v1
    v_bfe_u32 v3, v1, 2, 2
    v_lshl_add_u32 v3, v6, 3, v3
    s_lshl_b32 s47, s45, 5
    v_add_u32 v3, s47, v3
    v_and_b32 v4, 1, v6
    v_lshlrev_b32 v4, 2, v4
    v_add_u32 v5, v3, v4
    v_xor_b32 v4, 4, v4
    v_add_u32 v4, v3, v4
    v_mul_u32_u24 v5, 160, v5
    v_lshl_add_u32 v8, v2, 3, v5
    v_mul_u32_u24 v4, 160, v4
    v_lshl_add_u32 v11, v2, 3, v4
    v_and_b32 v2, 15, v1
    v_and_b32 v3, 7, v1
    s_lshl_b32 s47, s45, 2
    v_or_b32 v4, s47, v6
    v_xor_b32 v3, v3, v4
    v_lshlrev_b32 v3, 4, v3
    v_lshl_add_u32 v14, v2, 7, v3
    s_lshl_b32 s47, s46, 12
    v_add_u32 v14, s47, v14
    v_add_u32 v9, 55296, v8
    v_add_u32 v12, 55296, v11
    v_add_u32 v15, 55296, v14
    v_add_u32 v10, 110592, v8
    v_add_u32 v13, 110592, v11
    v_add_u32 v16, 110592, v14
    v_mov_b32 v28, 0
    v_mov_b32 v29, 0
    v_mov_b32 v30, 0
    v_mov_b32 v31, 0
    v_mov_b32 v32, 0
    v_mov_b32 v33, 0
    v_mov_b32 v34, 0
    v_mov_b32 v35, 0
    v_mov_b32 v36, 0
    v_mov_b32 v37, 0
    v_mov_b32 v38, 0
    v_mov_b32 v39, 0
    v_mov_b32 v40, 0
    v_mov_b32 v41, 0
    v_mov_b32 v42, 0
    v_mov_b32 v43, 0
    v_mov_b32 v44, 0
    v_mov_b32 v45, 0
    v_mov_b32 v46, 0
    v_mov_b32 v47, 0
    v_mov_b32 v48, 0
    v_mov_b32 v49, 0
    v_mov_b32 v50, 0
    v_mov_b32 v51, 0
    v_mov_b32 v52, 0
    v_mov_b32 v53, 0
    v_mov_b32 v54, 0
    v_mov_b32 v55, 0
    v_mov_b32 v56, 0
    v_mov_b32 v57, 0
    v_mov_b32 v58, 0
    v_mov_b32 v59, 0
    v_mov_b32 v60, 0
    v_mov_b32 v61, 0
    v_mov_b32 v62, 0
    v_mov_b32 v63, 0
    v_mov_b32 v64, 0
    v_mov_b32 v65, 0
    v_mov_b32 v66, 0
    v_mov_b32 v67, 0
    s_barrier
    ds_read_b128 v[108:111], v14 offset:0
    ds_read_b128 v[112:115], v14 offset:2048
    ds_read_b64_tr_b16 v[68:69], v8 offset:8192
    ds_read_b64_tr_b16 v[70:71], v11 offset:8192
    ds_read_b64_tr_b16 v[72:73], v8 offset:8224
    ds_read_b64_tr_b16 v[74:75], v11 offset:8224
    ds_read_b64_tr_b16 v[76:77], v8 offset:8256
    ds_read_b64_tr_b16 v[78:79], v11 offset:8256
    ds_read_b64_tr_b16 v[80:81], v8 offset:8288
    ds_read_b64_tr_b16 v[82:83], v11 offset:8288
    ds_read_b64_tr_b16 v[84:85], v8 offset:8320
    ds_read_b64_tr_b16 v[86:87], v11 offset:8320
    s_waitcnt lgkmcnt(0)
    s_barrier
    v_mfma_f32_16x16x32_bf16 v[28:31], v[68:71], v[108:111], v[28:31]
    ds_read_b128 v[116:119], v14 offset:18432
    ds_read_b128 v[120:123], v14 offset:20480
    v_mfma_f32_16x16x32_bf16 v[48:51], v[68:71], v[112:115], v[48:51]
    ds_read_b64_tr_b16 v[88:89], v8 offset:26624
    v_mfma_f32_16x16x32_bf16 v[32:35], v[72:75], v[108:111], v[32:35]
    ds_read_b64_tr_b16 v[90:91], v11 offset:26624
    v_mfma_f32_16x16x32_bf16 v[52:55], v[72:75], v[112:115], v[52:55]
    ds_read_b64_tr_b16 v[92:93], v8 offset:26656
    v_mfma_f32_16x16x32_bf16 v[36:39], v[76:79], v[108:111], v[36:39]
    ds_read_b64_tr_b16 v[94:95], v11 offset:26656
    v_mfma_f32_16x16x32_bf16 v[56:59], v[76:79], v[112:115], v[56:59]
    ds_read_b64_tr_b16 v[96:97], v8 offset:26688
    ds_read_b64_tr_b16 v[98:99], v11 offset:26688
    v_mfma_f32_16x16x32_bf16 v[40:43], v[80:83], v[108:111], v[40:43]
    ds_read_b64_tr_b16 v[100:101], v8 offset:26720
    v_mfma_f32_16x16x32_bf16 v[60:63], v[80:83], v[112:115], v[60:63]
    ds_read_b64_tr_b16 v[102:103], v11 offset:26720
    v_mfma_f32_16x16x32_bf16 v[44:47], v[84:87], v[108:111], v[44:47]
    ds_read_b64_tr_b16 v[104:105], v8 offset:26752
    v_mfma_f32_16x16x32_bf16 v[64:67], v[84:87], v[112:115], v[64:67]
    ds_read_b64_tr_b16 v[106:107], v11 offset:26752
    s_waitcnt lgkmcnt(0)
    s_barrier
    v_mfma_f32_16x16x32_bf16 v[28:31], v[88:91], v[116:119], v[28:31]
    ds_read_b128 v[108:111], v14 offset:36864
    ds_read_b128 v[112:115], v14 offset:38912
    v_mfma_f32_16x16x32_bf16 v[48:51], v[88:91], v[120:123], v[48:51]
    ds_read_b64_tr_b16 v[68:69], v8 offset:45056
    v_mfma_f32_16x16x32_bf16 v[32:35], v[92:95], v[116:119], v[32:35]
    ds_read_b64_tr_b16 v[70:71], v11 offset:45056
    v_mfma_f32_16x16x32_bf16 v[52:55], v[92:95], v[120:123], v[52:55]
    ds_read_b64_tr_b16 v[72:73], v8 offset:45088
    v_mfma_f32_16x16x32_bf16 v[36:39], v[96:99], v[116:119], v[36:39]
    ds_read_b64_tr_b16 v[74:75], v11 offset:45088
    v_mfma_f32_16x16x32_bf16 v[56:59], v[96:99], v[120:123], v[56:59]
    ds_read_b64_tr_b16 v[76:77], v8 offset:45120
    ds_read_b64_tr_b16 v[78:79], v11 offset:45120
    v_mfma_f32_16x16x32_bf16 v[40:43], v[100:103], v[116:119], v[40:43]
    ds_read_b64_tr_b16 v[80:81], v8 offset:45152
    v_mfma_f32_16x16x32_bf16 v[60:63], v[100:103], v[120:123], v[60:63]
    ds_read_b64_tr_b16 v[82:83], v11 offset:45152
    v_mfma_f32_16x16x32_bf16 v[44:47], v[104:107], v[116:119], v[44:47]
    ds_read_b64_tr_b16 v[84:85], v8 offset:45184
    v_mfma_f32_16x16x32_bf16 v[64:67], v[104:107], v[120:123], v[64:67]
    ds_read_b64_tr_b16 v[86:87], v11 offset:45184
    s_waitcnt lgkmcnt(0)
    s_barrier
    v_mfma_f32_16x16x32_bf16 v[28:31], v[68:71], v[108:111], v[28:31]
    ds_read_b128 v[116:119], v15 offset:0
    ds_read_b128 v[120:123], v15 offset:2048
    v_mfma_f32_16x16x32_bf16 v[48:51], v[68:71], v[112:115], v[48:51]
    ds_read_b64_tr_b16 v[88:89], v9 offset:8192
    v_mfma_f32_16x16x32_bf16 v[32:35], v[72:75], v[108:111], v[32:35]
    ds_read_b64_tr_b16 v[90:91], v12 offset:8192
    v_mfma_f32_16x16x32_bf16 v[52:55], v[72:75], v[112:115], v[52:55]
    ds_read_b64_tr_b16 v[92:93], v9 offset:8224
    v_mfma_f32_16x16x32_bf16 v[36:39], v[76:79], v[108:111], v[36:39]
    ds_read_b64_tr_b16 v[94:95], v12 offset:8224
    v_mfma_f32_16x16x32_bf16 v[56:59], v[76:79], v[112:115], v[56:59]
    ds_read_b64_tr_b16 v[96:97], v9 offset:8256
    ds_read_b64_tr_b16 v[98:99], v12 offset:8256
    v_mfma_f32_16x16x32_bf16 v[40:43], v[80:83], v[108:111], v[40:43]
    ds_read_b64_tr_b16 v[100:101], v9 offset:8288
    v_mfma_f32_16x16x32_bf16 v[60:63], v[80:83], v[112:115], v[60:63]
    ds_read_b64_tr_b16 v[102:103], v12 offset:8288
    v_mfma_f32_16x16x32_bf16 v[44:47], v[84:87], v[108:111], v[44:47]
    ds_read_b64_tr_b16 v[104:105], v9 offset:8320
    v_mfma_f32_16x16x32_bf16 v[64:67], v[84:87], v[112:115], v[64:67]
    ds_read_b64_tr_b16 v[106:107], v12 offset:8320
    s_waitcnt lgkmcnt(0)
    s_barrier
    v_mfma_f32_16x16x32_bf16 v[28:31], v[88:91], v[116:119], v[28:31]
    ds_read_b128 v[108:111], v15 offset:18432
    ds_read_b128 v[112:115], v15 offset:20480
    v_mfma_f32_16x16x32_bf16 v[48:51], v[88:91], v[120:123], v[48:51]
    ds_read_b64_tr_b16 v[68:69], v9 offset:26624
    v_mfma_f32_16x16x32_bf16 v[32:35], v[92:95], v[116:119], v[32:35]
    ds_read_b64_tr_b16 v[70:71], v12 offset:26624
    v_mfma_f32_16x16x32_bf16 v[52:55], v[92:95], v[120:123], v[52:55]
    ds_read_b64_tr_b16 v[72:73], v9 offset:26656
    v_mfma_f32_16x16x32_bf16 v[36:39], v[96:99], v[116:119], v[36:39]
    ds_read_b64_tr_b16 v[74:75], v12 offset:26656
    v_mfma_f32_16x16x32_bf16 v[56:59], v[96:99], v[120:123], v[56:59]
    ds_read_b64_tr_b16 v[76:77], v9 offset:26688
    ds_read_b64_tr_b16 v[78:79], v12 offset:26688
    v_mfma_f32_16x16x32_bf16 v[40:43], v[100:103], v[116:119], v[40:43]
    ds_read_b64_tr_b16 v[80:81], v9 offset:26720
    v_mfma_f32_16x16x32_bf16 v[60:63], v[100:103], v[120:123], v[60:63]
    ds_read_b64_tr_b16 v[82:83], v12 offset:26720
    v_mfma_f32_16x16x32_bf16 v[44:47], v[104:107], v[116:119], v[44:47]
    ds_read_b64_tr_b16 v[84:85], v9 offset:26752
    v_mfma_f32_16x16x32_bf16 v[64:67], v[104:107], v[120:123], v[64:67]
    ds_read_b64_tr_b16 v[86:87], v12 offset:26752
    s_waitcnt lgkmcnt(0)
    s_barrier
    v_mfma_f32_16x16x32_bf16 v[28:31], v[68:71], v[108:111], v[28:31]
    ds_read_b128 v[116:119], v15 offset:36864
    ds_read_b128 v[120:123], v15 offset:38912
    v_mfma_f32_16x16x32_bf16 v[48:51], v[68:71], v[112:115], v[48:51]
    ds_read_b64_tr_b16 v[88:89], v9 offset:45056
    v_mfma_f32_16x16x32_bf16 v[32:35], v[72:75], v[108:111], v[32:35]
    ds_read_b64_tr_b16 v[90:91], v12 offset:45056
    v_mfma_f32_16x16x32_bf16 v[52:55], v[72:75], v[112:115], v[52:55]
    ds_read_b64_tr_b16 v[92:93], v9 offset:45088
    v_mfma_f32_16x16x32_bf16 v[36:39], v[76:79], v[108:111], v[36:39]
    ds_read_b64_tr_b16 v[94:95], v12 offset:45088
    v_mfma_f32_16x16x32_bf16 v[56:59], v[76:79], v[112:115], v[56:59]
    ds_read_b64_tr_b16 v[96:97], v9 offset:45120
    ds_read_b64_tr_b16 v[98:99], v12 offset:45120
    v_mfma_f32_16x16x32_bf16 v[40:43], v[80:83], v[108:111], v[40:43]
    ds_read_b64_tr_b16 v[100:101], v9 offset:45152
    v_mfma_f32_16x16x32_bf16 v[60:63], v[80:83], v[112:115], v[60:63]
    ds_read_b64_tr_b16 v[102:103], v12 offset:45152
    v_mfma_f32_16x16x32_bf16 v[44:47], v[84:87], v[108:111], v[44:47]
    ds_read_b64_tr_b16 v[104:105], v9 offset:45184
    v_mfma_f32_16x16x32_bf16 v[64:67], v[84:87], v[112:115], v[64:67]
    ds_read_b64_tr_b16 v[106:107], v12 offset:45184
    s_waitcnt lgkmcnt(0)
    s_barrier
    v_mfma_f32_16x16x32_bf16 v[28:31], v[88:91], v[116:119], v[28:31]
    ds_read_b128 v[108:111], v16 offset:0
    ds_read_b128 v[112:115], v16 offset:2048
    v_mfma_f32_16x16x32_bf16 v[48:51], v[88:91], v[120:123], v[48:51]
    ds_read_b64_tr_b16 v[68:69], v10 offset:8192
    v_mfma_f32_16x16x32_bf16 v[32:35], v[92:95], v[116:119], v[32:35]
    ds_read_b64_tr_b16 v[70:71], v13 offset:8192
    v_mfma_f32_16x16x32_bf16 v[52:55], v[92:95], v[120:123], v[52:55]
    ds_read_b64_tr_b16 v[72:73], v10 offset:8224
    v_mfma_f32_16x16x32_bf16 v[36:39], v[96:99], v[116:119], v[36:39]
    ds_read_b64_tr_b16 v[74:75], v13 offset:8224
    v_mfma_f32_16x16x32_bf16 v[56:59], v[96:99], v[120:123], v[56:59]
    ds_read_b64_tr_b16 v[76:77], v10 offset:8256
    ds_read_b64_tr_b16 v[78:79], v13 offset:8256
    v_mfma_f32_16x16x32_bf16 v[40:43], v[100:103], v[116:119], v[40:43]
    ds_read_b64_tr_b16 v[80:81], v10 offset:8288
    v_mfma_f32_16x16x32_bf16 v[60:63], v[100:103], v[120:123], v[60:63]
    ds_read_b64_tr_b16 v[82:83], v13 offset:8288
    v_mfma_f32_16x16x32_bf16 v[44:47], v[104:107], v[116:119], v[44:47]
    ds_read_b64_tr_b16 v[84:85], v10 offset:8320
    v_mfma_f32_16x16x32_bf16 v[64:67], v[104:107], v[120:123], v[64:67]
    ds_read_b64_tr_b16 v[86:87], v13 offset:8320
    s_waitcnt lgkmcnt(0)
    s_barrier
    v_mfma_f32_16x16x32_bf16 v[28:31], v[68:71], v[108:111], v[28:31]
    ds_read_b128 v[116:119], v16 offset:18432
    ds_read_b128 v[120:123], v16 offset:20480
    v_mfma_f32_16x16x32_bf16 v[48:51], v[68:71], v[112:115], v[48:51]
    ds_read_b64_tr_b16 v[88:89], v10 offset:26624
    v_mfma_f32_16x16x32_bf16 v[32:35], v[72:75], v[108:111], v[32:35]
    ds_read_b64_tr_b16 v[90:91], v13 offset:26624
    v_mfma_f32_16x16x32_bf16 v[52:55], v[72:75], v[112:115], v[52:55]
    ds_read_b64_tr_b16 v[92:93], v10 offset:26656
    v_mfma_f32_16x16x32_bf16 v[36:39], v[76:79], v[108:111], v[36:39]
    ds_read_b64_tr_b16 v[94:95], v13 offset:26656
    v_mfma_f32_16x16x32_bf16 v[56:59], v[76:79], v[112:115], v[56:59]
    ds_read_b64_tr_b16 v[96:97], v10 offset:26688
    ds_read_b64_tr_b16 v[98:99], v13 offset:26688
    v_mfma_f32_16x16x32_bf16 v[40:43], v[80:83], v[108:111], v[40:43]
    ds_read_b64_tr_b16 v[100:101], v10 offset:26720
    v_mfma_f32_16x16x32_bf16 v[60:63], v[80:83], v[112:115], v[60:63]
    ds_read_b64_tr_b16 v[102:103], v13 offset:26720
    v_mfma_f32_16x16x32_bf16 v[44:47], v[84:87], v[108:111], v[44:47]
    ds_read_b64_tr_b16 v[104:105], v10 offset:26752
    v_mfma_f32_16x16x32_bf16 v[64:67], v[84:87], v[112:115], v[64:67]
    ds_read_b64_tr_b16 v[106:107], v13 offset:26752
    s_waitcnt lgkmcnt(0)
    s_barrier
    v_mfma_f32_16x16x32_bf16 v[28:31], v[88:91], v[116:119], v[28:31]
    ds_read_b128 v[108:111], v14 offset:0
    ds_read_b128 v[112:115], v14 offset:2048
    v_mfma_f32_16x16x32_bf16 v[48:51], v[88:91], v[120:123], v[48:51]
    ds_read_b64_tr_b16 v[68:69], v8 offset:8192
    v_mfma_f32_16x16x32_bf16 v[32:35], v[92:95], v[116:119], v[32:35]
    ds_read_b64_tr_b16 v[70:71], v11 offset:8192
    v_mfma_f32_16x16x32_bf16 v[52:55], v[92:95], v[120:123], v[52:55]
    ds_read_b64_tr_b16 v[72:73], v8 offset:8224
    v_mfma_f32_16x16x32_bf16 v[36:39], v[96:99], v[116:119], v[36:39]
    ds_read_b64_tr_b16 v[74:75], v11 offset:8224
    v_mfma_f32_16x16x32_bf16 v[56:59], v[96:99], v[120:123], v[56:59]
    ds_read_b64_tr_b16 v[76:77], v8 offset:8256
    ds_read_b64_tr_b16 v[78:79], v11 offset:8256
    v_mfma_f32_16x16x32_bf16 v[40:43], v[100:103], v[116:119], v[40:43]
    ds_read_b64_tr_b16 v[80:81], v8 offset:8288
    v_mfma_f32_16x16x32_bf16 v[60:63], v[100:103], v[120:123], v[60:63]
    ds_read_b64_tr_b16 v[82:83], v11 offset:8288
    v_mfma_f32_16x16x32_bf16 v[44:47], v[104:107], v[116:119], v[44:47]
    ds_read_b64_tr_b16 v[84:85], v8 offset:8320
    v_mfma_f32_16x16x32_bf16 v[64:67], v[104:107], v[120:123], v[64:67]
    ds_read_b64_tr_b16 v[86:87], v11 offset:8320
    s_waitcnt lgkmcnt(0)
    s_barrier
    v_mfma_f32_16x16x32_bf16 v[28:31], v[68:71], v[108:111], v[28:31]
    ds_read_b128 v[116:119], v14 offset:18432
    ds_read_b128 v[120:123], v14 offset:20480
    v_mfma_f32_16x16x32_bf16 v[48:51], v[68:71], v[112:115], v[48:51]
    ds_read_b64_tr_b16 v[88:89], v8 offset:26624
    v_mfma_f32_16x16x32_bf16 v[32:35], v[72:75], v[108:111], v[32:35]
    ds_read_b64_tr_b16 v[90:91], v11 offset:26624
    v_mfma_f32_16x16x32_bf16 v[52:55], v[72:75], v[112:115], v[52:55]
    ds_read_b64_tr_b16 v[92:93], v8 offset:26656
    v_mfma_f32_16x16x32_bf16 v[36:39], v[76:79], v[108:111], v[36:39]
    ds_read_b64_tr_b16 v[94:95], v11 offset:26656
    v_mfma_f32_16x16x32_bf16 v[56:59], v[76:79], v[112:115], v[56:59]
    ds_read_b64_tr_b16 v[96:97], v8 offset:26688
    ds_read_b64_tr_b16 v[98:99], v11 offset:26688
    v_mfma_f32_16x16x32_bf16 v[40:43], v[80:83], v[108:111], v[40:43]
    ds_read_b64_tr_b16 v[100:101], v8 offset:26720
    v_mfma_f32_16x16x32_bf16 v[60:63], v[80:83], v[112:115], v[60:63]
    ds_read_b64_tr_b16 v[102:103], v11 offset:26720
    v_mfma_f32_16x16x32_bf16 v[44:47], v[84:87], v[108:111], v[44:47]
    ds_read_b64_tr_b16 v[104:105], v8 offset:26752
    v_mfma_f32_16x16x32_bf16 v[64:67], v[84:87], v[112:115], v[64:67]
    ds_read_b64_tr_b16 v[106:107], v11 offset:26752
    s_waitcnt lgkmcnt(0)
    s_barrier
    v_mfma_f32_16x16x32_bf16 v[28:31], v[88:91], v[116:119], v[28:31]
    ds_read_b128 v[108:111], v14 offset:36864
    ds_read_b128 v[112:115], v14 offset:38912
    v_mfma_f32_16x16x32_bf16 v[48:51], v[88:91], v[120:123], v[48:51]
    ds_read_b64_tr_b16 v[68:69], v8 offset:45056
    v_mfma_f32_16x16x32_bf16 v[32:35], v[92:95], v[116:119], v[32:35]
    ds_read_b64_tr_b16 v[70:71], v11 offset:45056
    v_mfma_f32_16x16x32_bf16 v[52:55], v[92:95], v[120:123], v[52:55]
    ds_read_b64_tr_b16 v[72:73], v8 offset:45088
    v_mfma_f32_16x16x32_bf16 v[36:39], v[96:99], v[116:119], v[36:39]
    ds_read_b64_tr_b16 v[74:75], v11 offset:45088
    v_mfma_f32_16x16x32_bf16 v[56:59], v[96:99], v[120:123], v[56:59]
    ds_read_b64_tr_b16 v[76:77], v8 offset:45120
    ds_read_b64_tr_b16 v[78:79], v11 offset:45120
    v_mfma_f32_16x16x32_bf16 v[40:43], v[100:103], v[116:119], v[40:43]
    ds_read_b64_tr_b16 v[80:81], v8 offset:45152
    v_mfma_f32_16x16x32_bf16 v[60:63], v[100:103], v[120:123], v[60:63]
    ds_read_b64_tr_b16 v[82:83], v11 offset:45152
    v_mfma_f32_16x16x32_bf16 v[44:47], v[104:107], v[116:119], v[44:47]
    ds_read_b64_tr_b16 v[84:85], v8 offset:45184
    v_mfma_f32_16x16x32_bf16 v[64:67], v[104:107], v[120:123], v[64:67]
    ds_read_b64_tr_b16 v[86:87], v11 offset:45184
    s_waitcnt lgkmcnt(0)
    s_barrier
    v_mfma_f32_16x16x32_bf16 v[28:31], v[68:71], v[108:111], v[28:31]
    ds_read_b128 v[116:119], v15 offset:0
    ds_read_b128 v[120:123], v15 offset:2048
    v_mfma_f32_16x16x32_bf16 v[48:51], v[68:71], v[112:115], v[48:51]
    ds_read_b64_tr_b16 v[88:89], v9 offset:8192
    v_mfma_f32_16x16x32_bf16 v[32:35], v[72:75], v[108:111], v[32:35]
    ds_read_b64_tr_b16 v[90:91], v12 offset:8192
    v_mfma_f32_16x16x32_bf16 v[52:55], v[72:75], v[112:115], v[52:55]
    ds_read_b64_tr_b16 v[92:93], v9 offset:8224
    v_mfma_f32_16x16x32_bf16 v[36:39], v[76:79], v[108:111], v[36:39]
    ds_read_b64_tr_b16 v[94:95], v12 offset:8224
    v_mfma_f32_16x16x32_bf16 v[56:59], v[76:79], v[112:115], v[56:59]
    ds_read_b64_tr_b16 v[96:97], v9 offset:8256
    ds_read_b64_tr_b16 v[98:99], v12 offset:8256
    v_mfma_f32_16x16x32_bf16 v[40:43], v[80:83], v[108:111], v[40:43]
    ds_read_b64_tr_b16 v[100:101], v9 offset:8288
    v_mfma_f32_16x16x32_bf16 v[60:63], v[80:83], v[112:115], v[60:63]
    ds_read_b64_tr_b16 v[102:103], v12 offset:8288
    v_mfma_f32_16x16x32_bf16 v[44:47], v[84:87], v[108:111], v[44:47]
    ds_read_b64_tr_b16 v[104:105], v9 offset:8320
    v_mfma_f32_16x16x32_bf16 v[64:67], v[84:87], v[112:115], v[64:67]
    ds_read_b64_tr_b16 v[106:107], v12 offset:8320
    s_waitcnt lgkmcnt(0)
    s_barrier
    v_mfma_f32_16x16x32_bf16 v[28:31], v[88:91], v[116:119], v[28:31]
    ds_read_b128 v[108:111], v15 offset:18432
    ds_read_b128 v[112:115], v15 offset:20480
    v_mfma_f32_16x16x32_bf16 v[48:51], v[88:91], v[120:123], v[48:51]
    ds_read_b64_tr_b16 v[68:69], v9 offset:26624
    v_mfma_f32_16x16x32_bf16 v[32:35], v[92:95], v[116:119], v[32:35]
    ds_read_b64_tr_b16 v[70:71], v12 offset:26624
    v_mfma_f32_16x16x32_bf16 v[52:55], v[92:95], v[120:123], v[52:55]
    ds_read_b64_tr_b16 v[72:73], v9 offset:26656
    v_mfma_f32_16x16x32_bf16 v[36:39], v[96:99], v[116:119], v[36:39]
    ds_read_b64_tr_b16 v[74:75], v12 offset:26656
    v_mfma_f32_16x16x32_bf16 v[56:59], v[96:99], v[120:123], v[56:59]
    ds_read_b64_tr_b16 v[76:77], v9 offset:26688
    ds_read_b64_tr_b16 v[78:79], v12 offset:26688
    v_mfma_f32_16x16x32_bf16 v[40:43], v[100:103], v[116:119], v[40:43]
    ds_read_b64_tr_b16 v[80:81], v9 offset:26720
    v_mfma_f32_16x16x32_bf16 v[60:63], v[100:103], v[120:123], v[60:63]
    ds_read_b64_tr_b16 v[82:83], v12 offset:26720
    v_mfma_f32_16x16x32_bf16 v[44:47], v[104:107], v[116:119], v[44:47]
    ds_read_b64_tr_b16 v[84:85], v9 offset:26752
    v_mfma_f32_16x16x32_bf16 v[64:67], v[104:107], v[120:123], v[64:67]
    ds_read_b64_tr_b16 v[86:87], v12 offset:26752
    s_waitcnt lgkmcnt(0)
    s_barrier
    v_mfma_f32_16x16x32_bf16 v[28:31], v[68:71], v[108:111], v[28:31]
    ds_read_b128 v[116:119], v15 offset:36864
    ds_read_b128 v[120:123], v15 offset:38912
    v_mfma_f32_16x16x32_bf16 v[48:51], v[68:71], v[112:115], v[48:51]
    ds_read_b64_tr_b16 v[88:89], v9 offset:45056
    v_mfma_f32_16x16x32_bf16 v[32:35], v[72:75], v[108:111], v[32:35]
    ds_read_b64_tr_b16 v[90:91], v12 offset:45056
    v_mfma_f32_16x16x32_bf16 v[52:55], v[72:75], v[112:115], v[52:55]
    ds_read_b64_tr_b16 v[92:93], v9 offset:45088
    v_mfma_f32_16x16x32_bf16 v[36:39], v[76:79], v[108:111], v[36:39]
    ds_read_b64_tr_b16 v[94:95], v12 offset:45088
    v_mfma_f32_16x16x32_bf16 v[56:59], v[76:79], v[112:115], v[56:59]
    ds_read_b64_tr_b16 v[96:97], v9 offset:45120
    ds_read_b64_tr_b16 v[98:99], v12 offset:45120
    v_mfma_f32_16x16x32_bf16 v[40:43], v[80:83], v[108:111], v[40:43]
    ds_read_b64_tr_b16 v[100:101], v9 offset:45152
    v_mfma_f32_16x16x32_bf16 v[60:63], v[80:83], v[112:115], v[60:63]
    ds_read_b64_tr_b16 v[102:103], v12 offset:45152
    v_mfma_f32_16x16x32_bf16 v[44:47], v[84:87], v[108:111], v[44:47]
    ds_read_b64_tr_b16 v[104:105], v9 offset:45184
    v_mfma_f32_16x16x32_bf16 v[64:67], v[84:87], v[112:115], v[64:67]
    ds_read_b64_tr_b16 v[106:107], v12 offset:45184
    s_waitcnt lgkmcnt(0)
    s_barrier
    v_mfma_f32_16x16x32_bf16 v[28:31], v[88:91], v[116:119], v[28:31]
    ds_read_b128 v[108:111], v16 offset:0
    ds_read_b128 v[112:115], v16 offset:2048
    v_mfma_f32_16x16x32_bf16 v[48:51], v[88:91], v[120:123], v[48:51]
    ds_read_b64_tr_b16 v[68:69], v10 offset:8192
    v_mfma_f32_16x16x32_bf16 v[32:35], v[92:95], v[116:119], v[32:35]
    ds_read_b64_tr_b16 v[70:71], v13 offset:8192
    v_mfma_f32_16x16x32_bf16 v[52:55], v[92:95], v[120:123], v[52:55]
    ds_read_b64_tr_b16 v[72:73], v10 offset:8224
    v_mfma_f32_16x16x32_bf16 v[36:39], v[96:99], v[116:119], v[36:39]
    ds_read_b64_tr_b16 v[74:75], v13 offset:8224
    v_mfma_f32_16x16x32_bf16 v[56:59], v[96:99], v[120:123], v[56:59]
    ds_read_b64_tr_b16 v[76:77], v10 offset:8256
    ds_read_b64_tr_b16 v[78:79], v13 offset:8256
    v_mfma_f32_16x16x32_bf16 v[40:43], v[100:103], v[116:119], v[40:43]
    ds_read_b64_tr_b16 v[80:81], v10 offset:8288
    v_mfma_f32_16x16x32_bf16 v[60:63], v[100:103], v[120:123], v[60:63]
    ds_read_b64_tr_b16 v[82:83], v13 offset:8288
    v_mfma_f32_16x16x32_bf16 v[44:47], v[104:107], v[116:119], v[44:47]
    ds_read_b64_tr_b16 v[84:85], v10 offset:8320
    v_mfma_f32_16x16x32_bf16 v[64:67], v[104:107], v[120:123], v[64:67]
    ds_read_b64_tr_b16 v[86:87], v13 offset:8320
    s_waitcnt lgkmcnt(0)
    s_barrier
    v_mfma_f32_16x16x32_bf16 v[28:31], v[68:71], v[108:111], v[28:31]
    ds_read_b128 v[116:119], v16 offset:18432
    ds_read_b128 v[120:123], v16 offset:20480
    v_mfma_f32_16x16x32_bf16 v[48:51], v[68:71], v[112:115], v[48:51]
    ds_read_b64_tr_b16 v[88:89], v10 offset:26624
    v_mfma_f32_16x16x32_bf16 v[32:35], v[72:75], v[108:111], v[32:35]
    ds_read_b64_tr_b16 v[90:91], v13 offset:26624
    v_mfma_f32_16x16x32_bf16 v[52:55], v[72:75], v[112:115], v[52:55]
    ds_read_b64_tr_b16 v[92:93], v10 offset:26656
    v_mfma_f32_16x16x32_bf16 v[36:39], v[76:79], v[108:111], v[36:39]
    ds_read_b64_tr_b16 v[94:95], v13 offset:26656
    v_mfma_f32_16x16x32_bf16 v[56:59], v[76:79], v[112:115], v[56:59]
    ds_read_b64_tr_b16 v[96:97], v10 offset:26688
    ds_read_b64_tr_b16 v[98:99], v13 offset:26688
    v_mfma_f32_16x16x32_bf16 v[40:43], v[80:83], v[108:111], v[40:43]
    ds_read_b64_tr_b16 v[100:101], v10 offset:26720
    v_mfma_f32_16x16x32_bf16 v[60:63], v[80:83], v[112:115], v[60:63]
    ds_read_b64_tr_b16 v[102:103], v13 offset:26720
    v_mfma_f32_16x16x32_bf16 v[44:47], v[84:87], v[108:111], v[44:47]
    ds_read_b64_tr_b16 v[104:105], v10 offset:26752
    v_mfma_f32_16x16x32_bf16 v[64:67], v[84:87], v[112:115], v[64:67]
    ds_read_b64_tr_b16 v[106:107], v13 offset:26752
    s_waitcnt lgkmcnt(0)
    s_barrier
    v_mfma_f32_16x16x32_bf16 v[28:31], v[88:91], v[116:119], v[28:31]
    ds_read_b128 v[108:111], v14 offset:0
    ds_read_b128 v[112:115], v14 offset:2048
    v_mfma_f32_16x16x32_bf16 v[48:51], v[88:91], v[120:123], v[48:51]
    ds_read_b64_tr_b16 v[68:69], v8 offset:8192
    v_mfma_f32_16x16x32_bf16 v[32:35], v[92:95], v[116:119], v[32:35]
    ds_read_b64_tr_b16 v[70:71], v11 offset:8192
    v_mfma_f32_16x16x32_bf16 v[52:55], v[92:95], v[120:123], v[52:55]
    ds_read_b64_tr_b16 v[72:73], v8 offset:8224
    v_mfma_f32_16x16x32_bf16 v[36:39], v[96:99], v[116:119], v[36:39]
    ds_read_b64_tr_b16 v[74:75], v11 offset:8224
    v_mfma_f32_16x16x32_bf16 v[56:59], v[96:99], v[120:123], v[56:59]
    ds_read_b64_tr_b16 v[76:77], v8 offset:8256
    ds_read_b64_tr_b16 v[78:79], v11 offset:8256
    v_mfma_f32_16x16x32_bf16 v[40:43], v[100:103], v[116:119], v[40:43]
    ds_read_b64_tr_b16 v[80:81], v8 offset:8288
    v_mfma_f32_16x16x32_bf16 v[60:63], v[100:103], v[120:123], v[60:63]
    ds_read_b64_tr_b16 v[82:83], v11 offset:8288
    v_mfma_f32_16x16x32_bf16 v[44:47], v[104:107], v[116:119], v[44:47]
    ds_read_b64_tr_b16 v[84:85], v8 offset:8320
    v_mfma_f32_16x16x32_bf16 v[64:67], v[104:107], v[120:123], v[64:67]
    ds_read_b64_tr_b16 v[86:87], v11 offset:8320
    s_waitcnt lgkmcnt(0)
    s_barrier
    v_mfma_f32_16x16x32_bf16 v[28:31], v[68:71], v[108:111], v[28:31]
    ds_read_b128 v[116:119], v14 offset:18432
    ds_read_b128 v[120:123], v14 offset:20480
    v_mfma_f32_16x16x32_bf16 v[48:51], v[68:71], v[112:115], v[48:51]
    ds_read_b64_tr_b16 v[88:89], v8 offset:26624
    v_mfma_f32_16x16x32_bf16 v[32:35], v[72:75], v[108:111], v[32:35]
    ds_read_b64_tr_b16 v[90:91], v11 offset:26624
    v_mfma_f32_16x16x32_bf16 v[52:55], v[72:75], v[112:115], v[52:55]
    ds_read_b64_tr_b16 v[92:93], v8 offset:26656
    v_mfma_f32_16x16x32_bf16 v[36:39], v[76:79], v[108:111], v[36:39]
    ds_read_b64_tr_b16 v[94:95], v11 offset:26656
    v_mfma_f32_16x16x32_bf16 v[56:59], v[76:79], v[112:115], v[56:59]
    ds_read_b64_tr_b16 v[96:97], v8 offset:26688
    ds_read_b64_tr_b16 v[98:99], v11 offset:26688
    v_mfma_f32_16x16x32_bf16 v[40:43], v[80:83], v[108:111], v[40:43]
    ds_read_b64_tr_b16 v[100:101], v8 offset:26720
    v_mfma_f32_16x16x32_bf16 v[60:63], v[80:83], v[112:115], v[60:63]
    ds_read_b64_tr_b16 v[102:103], v11 offset:26720
    v_mfma_f32_16x16x32_bf16 v[44:47], v[84:87], v[108:111], v[44:47]
    ds_read_b64_tr_b16 v[104:105], v8 offset:26752
    v_mfma_f32_16x16x32_bf16 v[64:67], v[84:87], v[112:115], v[64:67]
    ds_read_b64_tr_b16 v[106:107], v11 offset:26752
    s_waitcnt lgkmcnt(0)
    s_barrier
    v_mfma_f32_16x16x32_bf16 v[28:31], v[88:91], v[116:119], v[28:31]
    ds_read_b128 v[108:111], v14 offset:36864
    ds_read_b128 v[112:115], v14 offset:38912
    v_mfma_f32_16x16x32_bf16 v[48:51], v[88:91], v[120:123], v[48:51]
    ds_read_b64_tr_b16 v[68:69], v8 offset:45056
    v_mfma_f32_16x16x32_bf16 v[32:35], v[92:95], v[116:119], v[32:35]
    ds_read_b64_tr_b16 v[70:71], v11 offset:45056
    v_mfma_f32_16x16x32_bf16 v[52:55], v[92:95], v[120:123], v[52:55]
    ds_read_b64_tr_b16 v[72:73], v8 offset:45088
    v_mfma_f32_16x16x32_bf16 v[36:39], v[96:99], v[116:119], v[36:39]
    ds_read_b64_tr_b16 v[74:75], v11 offset:45088
    v_mfma_f32_16x16x32_bf16 v[56:59], v[96:99], v[120:123], v[56:59]
    ds_read_b64_tr_b16 v[76:77], v8 offset:45120
    ds_read_b64_tr_b16 v[78:79], v11 offset:45120
    v_mfma_f32_16x16x32_bf16 v[40:43], v[100:103], v[116:119], v[40:43]
    ds_read_b64_tr_b16 v[80:81], v8 offset:45152
    v_mfma_f32_16x16x32_bf16 v[60:63], v[100:103], v[120:123], v[60:63]
    ds_read_b64_tr_b16 v[82:83], v11 offset:45152
    v_mfma_f32_16x16x32_bf16 v[44:47], v[104:107], v[116:119], v[44:47]
    ds_read_b64_tr_b16 v[84:85], v8 offset:45184
    v_mfma_f32_16x16x32_bf16 v[64:67], v[104:107], v[120:123], v[64:67]
    ds_read_b64_tr_b16 v[86:87], v11 offset:45184
    s_waitcnt lgkmcnt(0)
    s_barrier
    v_mfma_f32_16x16x32_bf16 v[28:31], v[68:71], v[108:111], v[28:31]
    ds_read_b128 v[116:119], v15 offset:0
    ds_read_b128 v[120:123], v15 offset:2048
    v_mfma_f32_16x16x32_bf16 v[48:51], v[68:71], v[112:115], v[48:51]
    ds_read_b64_tr_b16 v[88:89], v9 offset:8192
    v_mfma_f32_16x16x32_bf16 v[32:35], v[72:75], v[108:111], v[32:35]
    ds_read_b64_tr_b16 v[90:91], v12 offset:8192
    v_mfma_f32_16x16x32_bf16 v[52:55], v[72:75], v[112:115], v[52:55]
    ds_read_b64_tr_b16 v[92:93], v9 offset:8224
    v_mfma_f32_16x16x32_bf16 v[36:39], v[76:79], v[108:111], v[36:39]
    ds_read_b64_tr_b16 v[94:95], v12 offset:8224
    v_mfma_f32_16x16x32_bf16 v[56:59], v[76:79], v[112:115], v[56:59]
    ds_read_b64_tr_b16 v[96:97], v9 offset:8256
    ds_read_b64_tr_b16 v[98:99], v12 offset:8256
    v_mfma_f32_16x16x32_bf16 v[40:43], v[80:83], v[108:111], v[40:43]
    ds_read_b64_tr_b16 v[100:101], v9 offset:8288
    v_mfma_f32_16x16x32_bf16 v[60:63], v[80:83], v[112:115], v[60:63]
    ds_read_b64_tr_b16 v[102:103], v12 offset:8288
    v_mfma_f32_16x16x32_bf16 v[44:47], v[84:87], v[108:111], v[44:47]
    ds_read_b64_tr_b16 v[104:105], v9 offset:8320
    v_mfma_f32_16x16x32_bf16 v[64:67], v[84:87], v[112:115], v[64:67]
    ds_read_b64_tr_b16 v[106:107], v12 offset:8320
    s_waitcnt lgkmcnt(0)
    s_barrier
    v_mfma_f32_16x16x32_bf16 v[28:31], v[88:91], v[116:119], v[28:31]
    ds_read_b128 v[108:111], v15 offset:18432
    ds_read_b128 v[112:115], v15 offset:20480
    v_mfma_f32_16x16x32_bf16 v[48:51], v[88:91], v[120:123], v[48:51]
    ds_read_b64_tr_b16 v[68:69], v9 offset:26624
    v_mfma_f32_16x16x32_bf16 v[32:35], v[92:95], v[116:119], v[32:35]
    ds_read_b64_tr_b16 v[70:71], v12 offset:26624
    v_mfma_f32_16x16x32_bf16 v[52:55], v[92:95], v[120:123], v[52:55]
    ds_read_b64_tr_b16 v[72:73], v9 offset:26656
    v_mfma_f32_16x16x32_bf16 v[36:39], v[96:99], v[116:119], v[36:39]
    ds_read_b64_tr_b16 v[74:75], v12 offset:26656
    v_mfma_f32_16x16x32_bf16 v[56:59], v[96:99], v[120:123], v[56:59]
    ds_read_b64_tr_b16 v[76:77], v9 offset:26688
    ds_read_b64_tr_b16 v[78:79], v12 offset:26688
    v_mfma_f32_16x16x32_bf16 v[40:43], v[100:103], v[116:119], v[40:43]
    ds_read_b64_tr_b16 v[80:81], v9 offset:26720
    v_mfma_f32_16x16x32_bf16 v[60:63], v[100:103], v[120:123], v[60:63]
    ds_read_b64_tr_b16 v[82:83], v12 offset:26720
    v_mfma_f32_16x16x32_bf16 v[44:47], v[104:107], v[116:119], v[44:47]
    ds_read_b64_tr_b16 v[84:85], v9 offset:26752
    v_mfma_f32_16x16x32_bf16 v[64:67], v[104:107], v[120:123], v[64:67]
    ds_read_b64_tr_b16 v[86:87], v12 offset:26752
    s_waitcnt lgkmcnt(0)
    s_barrier
    buffer_load_dwordx2 v[18:19], v7, s[24:27], s39 offen offset:0
    buffer_load_dwordx2 v[20:21], v7, s[24:27], s39 offen offset:32
    buffer_load_dwordx2 v[22:23], v7, s[24:27], s39 offen offset:64
    buffer_load_dwordx2 v[24:25], v7, s[24:27], s39 offen offset:96
    buffer_load_dwordx2 v[26:27], v7, s[24:27], s39 offen offset:128
    v_mfma_f32_16x16x32_bf16 v[28:31], v[68:71], v[108:111], v[28:31]
    ds_read_b128 v[116:119], v15 offset:36864
    ds_read_b128 v[120:123], v15 offset:38912
    v_mfma_f32_16x16x32_bf16 v[48:51], v[68:71], v[112:115], v[48:51]
    ds_read_b64_tr_b16 v[88:89], v9 offset:45056
    v_mfma_f32_16x16x32_bf16 v[32:35], v[72:75], v[108:111], v[32:35]
    ds_read_b64_tr_b16 v[90:91], v12 offset:45056
    v_mfma_f32_16x16x32_bf16 v[52:55], v[72:75], v[112:115], v[52:55]
    ds_read_b64_tr_b16 v[92:93], v9 offset:45088
    v_mfma_f32_16x16x32_bf16 v[36:39], v[76:79], v[108:111], v[36:39]
    ds_read_b64_tr_b16 v[94:95], v12 offset:45088
    v_mfma_f32_16x16x32_bf16 v[56:59], v[76:79], v[112:115], v[56:59]
    ds_read_b64_tr_b16 v[96:97], v9 offset:45120
    ds_read_b64_tr_b16 v[98:99], v12 offset:45120
    v_mfma_f32_16x16x32_bf16 v[40:43], v[80:83], v[108:111], v[40:43]
    ds_read_b64_tr_b16 v[100:101], v9 offset:45152
    v_mfma_f32_16x16x32_bf16 v[60:63], v[80:83], v[112:115], v[60:63]
    ds_read_b64_tr_b16 v[102:103], v12 offset:45152
    v_mfma_f32_16x16x32_bf16 v[44:47], v[84:87], v[108:111], v[44:47]
    ds_read_b64_tr_b16 v[104:105], v9 offset:45184
    v_mfma_f32_16x16x32_bf16 v[64:67], v[84:87], v[112:115], v[64:67]
    ds_read_b64_tr_b16 v[106:107], v12 offset:45184
    s_waitcnt lgkmcnt(0)
    s_barrier
    v_mfma_f32_16x16x32_bf16 v[28:31], v[88:91], v[116:119], v[28:31]
    ds_read_b128 v[108:111], v16 offset:0
    ds_read_b128 v[112:115], v16 offset:2048
    v_mfma_f32_16x16x32_bf16 v[48:51], v[88:91], v[120:123], v[48:51]
    ds_read_b64_tr_b16 v[68:69], v10 offset:8192
    v_mfma_f32_16x16x32_bf16 v[32:35], v[92:95], v[116:119], v[32:35]
    ds_read_b64_tr_b16 v[70:71], v13 offset:8192
    v_mfma_f32_16x16x32_bf16 v[52:55], v[92:95], v[120:123], v[52:55]
    ds_read_b64_tr_b16 v[72:73], v10 offset:8224
    v_mfma_f32_16x16x32_bf16 v[36:39], v[96:99], v[116:119], v[36:39]
    ds_read_b64_tr_b16 v[74:75], v13 offset:8224
    v_mfma_f32_16x16x32_bf16 v[56:59], v[96:99], v[120:123], v[56:59]
    ds_read_b64_tr_b16 v[76:77], v10 offset:8256
    ds_read_b64_tr_b16 v[78:79], v13 offset:8256
    v_mfma_f32_16x16x32_bf16 v[40:43], v[100:103], v[116:119], v[40:43]
    ds_read_b64_tr_b16 v[80:81], v10 offset:8288
    v_mfma_f32_16x16x32_bf16 v[60:63], v[100:103], v[120:123], v[60:63]
    ds_read_b64_tr_b16 v[82:83], v13 offset:8288
    v_mfma_f32_16x16x32_bf16 v[44:47], v[104:107], v[116:119], v[44:47]
    ds_read_b64_tr_b16 v[84:85], v10 offset:8320
    v_mfma_f32_16x16x32_bf16 v[64:67], v[104:107], v[120:123], v[64:67]
    ds_read_b64_tr_b16 v[86:87], v13 offset:8320
    s_waitcnt lgkmcnt(0)
    s_barrier
    v_mfma_f32_16x16x32_bf16 v[28:31], v[68:71], v[108:111], v[28:31]
    ds_read_b128 v[116:119], v16 offset:18432
    ds_read_b128 v[120:123], v16 offset:20480
    v_mfma_f32_16x16x32_bf16 v[48:51], v[68:71], v[112:115], v[48:51]
    ds_read_b64_tr_b16 v[88:89], v10 offset:26624
    v_mfma_f32_16x16x32_bf16 v[32:35], v[72:75], v[108:111], v[32:35]
    ds_read_b64_tr_b16 v[90:91], v13 offset:26624
    v_mfma_f32_16x16x32_bf16 v[52:55], v[72:75], v[112:115], v[52:55]
    ds_read_b64_tr_b16 v[92:93], v10 offset:26656
    v_mfma_f32_16x16x32_bf16 v[36:39], v[76:79], v[108:111], v[36:39]
    ds_read_b64_tr_b16 v[94:95], v13 offset:26656
    v_mfma_f32_16x16x32_bf16 v[56:59], v[76:79], v[112:115], v[56:59]
    ds_read_b64_tr_b16 v[96:97], v10 offset:26688
    ds_read_b64_tr_b16 v[98:99], v13 offset:26688
    v_mfma_f32_16x16x32_bf16 v[40:43], v[80:83], v[108:111], v[40:43]
    ds_read_b64_tr_b16 v[100:101], v10 offset:26720
    v_mfma_f32_16x16x32_bf16 v[60:63], v[80:83], v[112:115], v[60:63]
    ds_read_b64_tr_b16 v[102:103], v13 offset:26720
    v_mfma_f32_16x16x32_bf16 v[44:47], v[84:87], v[108:111], v[44:47]
    ds_read_b64_tr_b16 v[104:105], v10 offset:26752
    v_mfma_f32_16x16x32_bf16 v[64:67], v[84:87], v[112:115], v[64:67]
    ds_read_b64_tr_b16 v[106:107], v13 offset:26752
    s_waitcnt lgkmcnt(0)
    s_barrier
    v_mfma_f32_16x16x32_bf16 v[28:31], v[88:91], v[116:119], v[28:31]
    ds_read_b128 v[108:111], v14 offset:0
    ds_read_b128 v[112:115], v14 offset:2048
    v_mfma_f32_16x16x32_bf16 v[48:51], v[88:91], v[120:123], v[48:51]
    ds_read_b64_tr_b16 v[68:69], v8 offset:8192
    v_mfma_f32_16x16x32_bf16 v[32:35], v[92:95], v[116:119], v[32:35]
    ds_read_b64_tr_b16 v[70:71], v11 offset:8192
    v_mfma_f32_16x16x32_bf16 v[52:55], v[92:95], v[120:123], v[52:55]
    ds_read_b64_tr_b16 v[72:73], v8 offset:8224
    v_mfma_f32_16x16x32_bf16 v[36:39], v[96:99], v[116:119], v[36:39]
    ds_read_b64_tr_b16 v[74:75], v11 offset:8224
    v_mfma_f32_16x16x32_bf16 v[56:59], v[96:99], v[120:123], v[56:59]
    ds_read_b64_tr_b16 v[76:77], v8 offset:8256
    ds_read_b64_tr_b16 v[78:79], v11 offset:8256
    v_mfma_f32_16x16x32_bf16 v[40:43], v[100:103], v[116:119], v[40:43]
    ds_read_b64_tr_b16 v[80:81], v8 offset:8288
    v_mfma_f32_16x16x32_bf16 v[60:63], v[100:103], v[120:123], v[60:63]
    ds_read_b64_tr_b16 v[82:83], v11 offset:8288
    v_mfma_f32_16x16x32_bf16 v[44:47], v[104:107], v[116:119], v[44:47]
    ds_read_b64_tr_b16 v[84:85], v8 offset:8320
    v_mfma_f32_16x16x32_bf16 v[64:67], v[104:107], v[120:123], v[64:67]
    ds_read_b64_tr_b16 v[86:87], v11 offset:8320
    s_waitcnt lgkmcnt(0)
    s_barrier
    v_mfma_f32_16x16x32_bf16 v[28:31], v[68:71], v[108:111], v[28:31]
    ds_read_b128 v[116:119], v14 offset:18432
    ds_read_b128 v[120:123], v14 offset:20480
    v_mfma_f32_16x16x32_bf16 v[48:51], v[68:71], v[112:115], v[48:51]
    ds_read_b64_tr_b16 v[88:89], v8 offset:26624
    v_mfma_f32_16x16x32_bf16 v[32:35], v[72:75], v[108:111], v[32:35]
    ds_read_b64_tr_b16 v[90:91], v11 offset:26624
    v_mfma_f32_16x16x32_bf16 v[52:55], v[72:75], v[112:115], v[52:55]
    ds_read_b64_tr_b16 v[92:93], v8 offset:26656
    v_mfma_f32_16x16x32_bf16 v[36:39], v[76:79], v[108:111], v[36:39]
    ds_read_b64_tr_b16 v[94:95], v11 offset:26656
    v_mfma_f32_16x16x32_bf16 v[56:59], v[76:79], v[112:115], v[56:59]
    ds_read_b64_tr_b16 v[96:97], v8 offset:26688
    ds_read_b64_tr_b16 v[98:99], v11 offset:26688
    v_mfma_f32_16x16x32_bf16 v[40:43], v[80:83], v[108:111], v[40:43]
    ds_read_b64_tr_b16 v[100:101], v8 offset:26720
    v_mfma_f32_16x16x32_bf16 v[60:63], v[80:83], v[112:115], v[60:63]
    ds_read_b64_tr_b16 v[102:103], v11 offset:26720
    v_mfma_f32_16x16x32_bf16 v[44:47], v[84:87], v[108:111], v[44:47]
    ds_read_b64_tr_b16 v[104:105], v8 offset:26752
    v_mfma_f32_16x16x32_bf16 v[64:67], v[84:87], v[112:115], v[64:67]
    ds_read_b64_tr_b16 v[106:107], v11 offset:26752
    s_waitcnt lgkmcnt(0)
    s_barrier
    v_mfma_f32_16x16x32_bf16 v[28:31], v[88:91], v[116:119], v[28:31]
    ds_read_b128 v[108:111], v14 offset:36864
    ds_read_b128 v[112:115], v14 offset:38912
    v_mfma_f32_16x16x32_bf16 v[48:51], v[88:91], v[120:123], v[48:51]
    ds_read_b64_tr_b16 v[68:69], v8 offset:45056
    v_mfma_f32_16x16x32_bf16 v[32:35], v[92:95], v[116:119], v[32:35]
    ds_read_b64_tr_b16 v[70:71], v11 offset:45056
    v_mfma_f32_16x16x32_bf16 v[52:55], v[92:95], v[120:123], v[52:55]
    ds_read_b64_tr_b16 v[72:73], v8 offset:45088
    v_mfma_f32_16x16x32_bf16 v[36:39], v[96:99], v[116:119], v[36:39]
    ds_read_b64_tr_b16 v[74:75], v11 offset:45088
    v_mfma_f32_16x16x32_bf16 v[56:59], v[96:99], v[120:123], v[56:59]
    ds_read_b64_tr_b16 v[76:77], v8 offset:45120
    ds_read_b64_tr_b16 v[78:79], v11 offset:45120
    v_mfma_f32_16x16x32_bf16 v[40:43], v[100:103], v[116:119], v[40:43]
    ds_read_b64_tr_b16 v[80:81], v8 offset:45152
    v_mfma_f32_16x16x32_bf16 v[60:63], v[100:103], v[120:123], v[60:63]
    ds_read_b64_tr_b16 v[82:83], v11 offset:45152
    v_mfma_f32_16x16x32_bf16 v[44:47], v[104:107], v[116:119], v[44:47]
    ds_read_b64_tr_b16 v[84:85], v8 offset:45184
    v_mfma_f32_16x16x32_bf16 v[64:67], v[104:107], v[120:123], v[64:67]
    ds_read_b64_tr_b16 v[86:87], v11 offset:45184
    s_waitcnt lgkmcnt(0)
    v_mfma_f32_16x16x32_bf16 v[28:31], v[68:71], v[108:111], v[28:31]
    v_mfma_f32_16x16x32_bf16 v[48:51], v[68:71], v[112:115], v[48:51]
    v_mfma_f32_16x16x32_bf16 v[32:35], v[72:75], v[108:111], v[32:35]
    v_mfma_f32_16x16x32_bf16 v[52:55], v[72:75], v[112:115], v[52:55]
    v_mfma_f32_16x16x32_bf16 v[36:39], v[76:79], v[108:111], v[36:39]
    v_mfma_f32_16x16x32_bf16 v[56:59], v[76:79], v[112:115], v[56:59]
    v_mfma_f32_16x16x32_bf16 v[40:43], v[80:83], v[108:111], v[40:43]
    v_mfma_f32_16x16x32_bf16 v[60:63], v[80:83], v[112:115], v[60:63]
    v_mfma_f32_16x16x32_bf16 v[44:47], v[84:87], v[108:111], v[44:47]
    v_mfma_f32_16x16x32_bf16 v[64:67], v[84:87], v[112:115], v[64:67]
    s_mul_i32 s47, s28, 5120
    s_add_u32 s47, s47, 55296
    v_lshlrev_b32 v4, 4, v1
    v_add_u32 v2, s47, v4
    s_xor_b32 s46, s28, 2
    s_mul_i32 s47, s46, 5120
    s_add_u32 s47, s47, 55296
    v_add_u32 v3, s47, v4
    s_cmp_eq_u32 s45, 0
    s_cbranch_scc1 k5_kh0
    ds_write_b128 v2, v[28:31] offset:0
    ds_write_b128 v2, v[32:35] offset:1024
    ds_write_b128 v2, v[36:39] offset:2048
    ds_write_b128 v2, v[40:43] offset:3072
    ds_write_b128 v2, v[44:47] offset:4096
    s_nop 1
    v_mov_b32 v28, v48
    v_mov_b32 v29, v49
    v_mov_b32 v30, v50
    v_mov_b32 v31, v51
    v_mov_b32 v32, v52
    v_mov_b32 v33, v53
    v_mov_b32 v34, v54
    v_mov_b32 v35, v55
    v_mov_b32 v36, v56
    v_mov_b32 v37, v57
    v_mov_b32 v38, v58
    v_mov_b32 v39, v59
    v_mov_b32 v40, v60
    v_mov_b32 v41, v61
    v_mov_b32 v42, v62
    v_mov_b32 v43, v63
    v_mov_b32 v44, v64
    v_mov_b32 v45, v65
    v_mov_b32 v46, v66
    v_mov_b32 v47, v67
    s_branch k5_red
k5_kh0:
    s_nop 7
    s_nop 7
    ds_write_b128 v2, v[48:51] offset:0
    ds_write_b128 v2, v[52:55] offset:1024
    ds_write_b128 v2, v[56:59] offset:2048
    ds_write_b128 v2, v[60:63] offset:3072
    ds_write_b128 v2, v[64:67] offset:4096
k5_red:
    s_waitcnt lgkmcnt(0)
    s_barrier
    ds_read_b128 v[68:71], v3 offset:0
    ds_read_b128 v[72:75], v3 offset:1024
    ds_read_b128 v[76:79], v3 offset:2048
    ds_read_b128 v[80:83], v3 offset:3072
    ds_read_b128 v[84:87], v3 offset:4096
    s_mov_b32 s42, 0xffff0000
    s_waitcnt vmcnt(0)
    s_waitcnt lgkmcnt(4)
    v_pk_add_f32 v[28:29], v[28:29], v[68:69]
    v_pk_add_f32 v[30:31], v[30:31], v[70:71]
    v_lshlrev_b32 v68, 16, v18
    v_lshlrev_b32 v70, 16, v19
    v_and_b32 v69, s42, v18
    v_and_b32 v71, s42, v19
    v_cvt_pk_bf16_f32 v28, 0, v28
    v_cvt_pk_bf16_f32 v30, 0, v30
    v_cvt_pk_bf16_f32 v29, 0, v29
    v_cvt_pk_bf16_f32 v31, 0, v31
    v_pk_add_f32 v[28:29], v[28:29], v[68:69]
    v_pk_add_f32 v[30:31], v[30:31], v[70:71]
    v_cvt_pk_bf16_f32 v18, v28, v29
    v_cvt_pk_bf16_f32 v19, v30, v31
    buffer_store_dwordx2 v[18:19], v7, s[16:19], s39 offen offset:0
    s_waitcnt lgkmcnt(3)
    v_pk_add_f32 v[32:33], v[32:33], v[72:73]
    v_pk_add_f32 v[34:35], v[34:35], v[74:75]
    v_lshlrev_b32 v72, 16, v20
    v_lshlrev_b32 v74, 16, v21
    v_and_b32 v73, s42, v20
    v_and_b32 v75, s42, v21
    v_cvt_pk_bf16_f32 v32, 0, v32
    v_cvt_pk_bf16_f32 v34, 0, v34
    v_cvt_pk_bf16_f32 v33, 0, v33
    v_cvt_pk_bf16_f32 v35, 0, v35
    v_pk_add_f32 v[32:33], v[32:33], v[72:73]
    v_pk_add_f32 v[34:35], v[34:35], v[74:75]
    v_cvt_pk_bf16_f32 v20, v32, v33
    v_cvt_pk_bf16_f32 v21, v34, v35
    buffer_store_dwordx2 v[20:21], v7, s[16:19], s39 offen offset:32
    s_waitcnt lgkmcnt(2)
    v_pk_add_f32 v[36:37], v[36:37], v[76:77]
    v_pk_add_f32 v[38:39], v[38:39], v[78:79]
    v_lshlrev_b32 v76, 16, v22
    v_lshlrev_b32 v78, 16, v23
    v_and_b32 v77, s42, v22
    v_and_b32 v79, s42, v23
    v_cvt_pk_bf16_f32 v36, 0, v36
    v_cvt_pk_bf16_f32 v38, 0, v38
    v_cvt_pk_bf16_f32 v37, 0, v37
    v_cvt_pk_bf16_f32 v39, 0, v39
    v_pk_add_f32 v[36:37], v[36:37], v[76:77]
    v_pk_add_f32 v[38:39], v[38:39], v[78:79]
    v_cvt_pk_bf16_f32 v22, v36, v37
    v_cvt_pk_bf16_f32 v23, v38, v39
    buffer_store_dwordx2 v[22:23], v7, s[16:19], s39 offen offset:64
    s_waitcnt lgkmcnt(1)
    v_pk_add_f32 v[40:41], v[40:41], v[80:81]
    v_pk_add_f32 v[42:43], v[42:43], v[82:83]
    v_lshlrev_b32 v80, 16, v24
    v_lshlrev_b32 v82, 16, v25
    v_and_b32 v81, s42, v24
    v_and_b32 v83, s42, v25
    v_cvt_pk_bf16_f32 v40, 0, v40
    v_cvt_pk_bf16_f32 v42, 0, v42
    v_cvt_pk_bf16_f32 v41, 0, v41
    v_cvt_pk_bf16_f32 v43, 0, v43
    v_pk_add_f32 v[40:41], v[40:41], v[80:81]
    v_pk_add_f32 v[42:43], v[42:43], v[82:83]
    v_cvt_pk_bf16_f32 v24, v40, v41
    v_cvt_pk_bf16_f32 v25, v42, v43
    buffer_store_dwordx2 v[24:25], v7, s[16:19], s39 offen offset:96
    s_waitcnt lgkmcnt(0)
    v_pk_add_f32 v[44:45], v[44:45], v[84:85]
    v_pk_add_f32 v[46:47], v[46:47], v[86:87]
    v_lshlrev_b32 v84, 16, v26
    v_lshlrev_b32 v86, 16, v27
    v_and_b32 v85, s42, v26
    v_and_b32 v87, s42, v27
    v_cvt_pk_bf16_f32 v44, 0, v44
    v_cvt_pk_bf16_f32 v46, 0, v46
    v_cvt_pk_bf16_f32 v45, 0, v45
    v_cvt_pk_bf16_f32 v47, 0, v47
    v_pk_add_f32 v[44:45], v[44:45], v[84:85]
    v_pk_add_f32 v[46:47], v[46:47], v[86:87]
    v_cvt_pk_bf16_f32 v26, v44, v45
    v_cvt_pk_bf16_f32 v27, v46, v47
    buffer_store_dwordx2 v[26:27], v7, s[16:19], s39 offen offset:128
    s_endpgm
k5_prod:
    s_setprio 3
    s_movk_i32 s33, 6554
    s_waitcnt lgkmcnt(0)
    s_add_u32 s12, s8, 0x1a00000
    s_addc_u32 s13, s9, 0
    s_mov_b32 s14, 0x21c000
    s_mov_b32 s15, 0x00020000
    s_add_u32 s20, s8, 0x1000000
    s_addc_u32 s21, s9, 0
    s_mov_b32 s22, 0x6c0000
    s_mov_b32 s23, 0x00020000
    s_cmp_eq_u32 s28, 5
    s_cbranch_scc1 k5_p1
    v_lshrrev_b32 v2, 3, v1
    v_and_b32 v3, 7, v1
    v_xor_b32 v4, v3, v2
    v_lshlrev_b32 v4, 4, v4
    v_mul_u32_u24 v5, 3456, v2
    v_add_u32 v7, v4, v5
    v_add_u32 v28, 0, v7
    v_add_u32 v29, 27648, v7
    v_add_u32 v30, 55296, v7
    v_add_u32 v31, 82944, v7
    v_add_u32 v32, 110592, v7
    v_add_u32 v33, 138240, v7
    v_add_u32 v34, 165888, v7
    v_add_u32 v35, 193536, v7
    v_lshlrev_b32 v36, 4, v1
    v_add_u32 v36, 0, v36
    s_mov_b32 m0, 0
    s_nop 0
    buffer_load_dwordx4 v28, s[20:23], s30 offen lds
    s_mov_b32 m0, 1024
    s_nop 0
    buffer_load_dwordx4 v29, s[20:23], s30 offen lds
    s_mov_b32 m0, 2048
    s_nop 0
    buffer_load_dwordx4 v30, s[20:23], s30 offen lds
    s_mov_b32 m0, 3072
    s_nop 0
    buffer_load_dwordx4 v31, s[20:23], s30 offen lds
    s_mov_b32 m0, 4096
    s_nop 0
    buffer_load_dwordx4 v32, s[20:23], s30 offen lds
    s_mov_b32 m0, 5120
    s_nop 0
    buffer_load_dwordx4 v33, s[20:23], s30 offen lds
    s_mov_b32 m0, 6144
    s_nop 0
    buffer_load_dwordx4 v34, s[20:23], s30 offen lds
    s_mov_b32 m0, 7168
    s_nop 0
    buffer_load_dwordx4 v35, s[20:23], s30 offen lds
    s_mov_b32 m0, 8192
    s_nop 0
    buffer_load_dwordx4 v36, s[12:15], s29 offen lds
    s_add_u32 s29, s29, 10240
    s_add_u32 s30, s30, 128
    s_add_u32 s44, s44, 1
    s_cmp_eq_u32 s44, 27
    s_cselect_b32 s44, 0, s44
    s_cselect_b32 s47, 276480, 0
    s_cselect_b32 s34, 3456, 0
    s_sub_u32 s29, s29, s47
    s_sub_u32 s30, s30, s34
    s_mov_b32 m0, 18432
    s_nop 0
    buffer_load_dwordx4 v28, s[20:23], s30 offen lds
    s_mov_b32 m0, 19456
    s_nop 0
    buffer_load_dwordx4 v29, s[20:23], s30 offen lds
    s_mov_b32 m0, 20480
    s_nop 0
    buffer_load_dwordx4 v30, s[20:23], s30 offen lds
    s_mov_b32 m0, 21504
    s_nop 0
    buffer_load_dwordx4 v31, s[20:23], s30 offen lds
    s_mov_b32 m0, 22528
    s_nop 0
    buffer_load_dwordx4 v32, s[20:23], s30 offen lds
    s_mov_b32 m0, 23552
    s_nop 0
    buffer_load_dwordx4 v33, s[20:23], s30 offen lds
    s_mov_b32 m0, 24576
    s_nop 0
    buffer_load_dwordx4 v34, s[20:23], s30 offen lds
    s_mov_b32 m0, 25600
    s_nop 0
    buffer_load_dwordx4 v35, s[20:23], s30 offen lds
    s_mov_b32 m0, 26624
    s_nop 0
    buffer_load_dwordx4 v36, s[12:15], s29 offen lds
    s_add_u32 s29, s29, 10240
    s_add_u32 s30, s30, 128
    s_add_u32 s44, s44, 1
    s_cmp_eq_u32 s44, 27
    s_cselect_b32 s44, 0, s44
    s_cselect_b32 s47, 276480, 0
    s_cselect_b32 s34, 3456, 0
    s_sub_u32 s29, s29, s47
    s_sub_u32 s30, s30, s34
    s_mov_b32 m0, 36864
    s_nop 0
    buffer_load_dwordx4 v28, s[20:23], s30 offen lds
    s_mov_b32 m0, 37888
    s_nop 0
    buffer_load_dwordx4 v29, s[20:23], s30 offen lds
    s_mov_b32 m0, 38912
    s_nop 0
    buffer_load_dwordx4 v30, s[20:23], s30 offen lds
    s_mov_b32 m0, 39936
    s_nop 0
    buffer_load_dwordx4 v31, s[20:23], s30 offen lds
    s_mov_b32 m0, 40960
    s_nop 0
    buffer_load_dwordx4 v32, s[20:23], s30 offen lds
    s_mov_b32 m0, 41984
    s_nop 0
    buffer_load_dwordx4 v33, s[20:23], s30 offen lds
    s_mov_b32 m0, 43008
    s_nop 0
    buffer_load_dwordx4 v34, s[20:23], s30 offen lds
    s_mov_b32 m0, 44032
    s_nop 0
    buffer_load_dwordx4 v35, s[20:23], s30 offen lds
    s_mov_b32 m0, 45056
    s_nop 0
    buffer_load_dwordx4 v36, s[12:15], s29 offen lds
    s_add_u32 s29, s29, 10240
    s_add_u32 s30, s30, 128
    s_add_u32 s44, s44, 1
    s_cmp_eq_u32 s44, 27
    s_cselect_b32 s44, 0, s44
    s_cselect_b32 s47, 276480, 0
    s_cselect_b32 s34, 3456, 0
    s_sub_u32 s29, s29, s47
    s_sub_u32 s30, s30, s34
    s_mov_b32 m0, 55296
    s_nop 0
    buffer_load_dwordx4 v28, s[20:23], s30 offen lds
    s_mov_b32 m0, 56320
    s_nop 0
    buffer_load_dwordx4 v29, s[20:23], s30 offen lds
    s_mov_b32 m0, 57344
    s_nop 0
    buffer_load_dwordx4 v30, s[20:23], s30 offen lds
    s_mov_b32 m0, 58368
    s_nop 0
    buffer_load_dwordx4 v31, s[20:23], s30 offen lds
    s_mov_b32 m0, 59392
    s_nop 0
    buffer_load_dwordx4 v32, s[20:23], s30 offen lds
    s_mov_b32 m0, 60416
    s_nop 0
    buffer_load_dwordx4 v33, s[20:23], s30 offen lds
    s_mov_b32 m0, 61440
    s_nop 0
    buffer_load_dwordx4 v34, s[20:23], s30 offen lds
    s_mov_b32 m0, 62464
    s_nop 0
    buffer_load_dwordx4 v35, s[20:23], s30 offen lds
    s_mov_b32 m0, 63488
    s_nop 0
    buffer_load_dwordx4 v36, s[12:15], s29 offen lds
    s_add_u32 s29, s29, 10240
    s_add_u32 s30, s30, 128
    s_add_u32 s44, s44, 1
    s_cmp_eq_u32 s44, 27
    s_cselect_b32 s44, 0, s44
    s_cselect_b32 s47, 276480, 0
    s_cselect_b32 s34, 3456, 0
    s_sub_u32 s29, s29, s47
    s_sub_u32 s30, s30, s34
    s_mov_b32 m0, 73728
    s_nop 0
    buffer_load_dwordx4 v28, s[20:23], s30 offen lds
    s_mov_b32 m0, 74752
    s_nop 0
    buffer_load_dwordx4 v29, s[20:23], s30 offen lds
    s_mov_b32 m0, 75776
    s_nop 0
    buffer_load_dwordx4 v30, s[20:23], s30 offen lds
    s_mov_b32 m0, 76800
    s_nop 0
    buffer_load_dwordx4 v31, s[20:23], s30 offen lds
    s_mov_b32 m0, 77824
    s_nop 0
    buffer_load_dwordx4 v32, s[20:23], s30 offen lds
    s_mov_b32 m0, 78848
    s_nop 0
    buffer_load_dwordx4 v33, s[20:23], s30 offen lds
    s_mov_b32 m0, 79872
    s_nop 0
    buffer_load_dwordx4 v34, s[20:23], s30 offen lds
    s_mov_b32 m0, 80896
    s_nop 0
    buffer_load_dwordx4 v35, s[20:23], s30 offen lds
    s_mov_b32 m0, 81920
    s_nop 0
    buffer_load_dwordx4 v36, s[12:15], s29 offen lds
    s_add_u32 s29, s29, 10240
    s_add_u32 s30, s30, 128
    s_add_u32 s44, s44, 1
    s_cmp_eq_u32 s44, 27
    s_cselect_b32 s44, 0, s44
    s_cselect_b32 s47, 276480, 0
    s_cselect_b32 s34, 3456, 0
    s_sub_u32 s29, s29, s47
    s_sub_u32 s30, s30, s34
    s_mov_b32 m0, 92160
    s_nop 0
    buffer_load_dwordx4 v28, s[20:23], s30 offen lds
    s_mov_b32 m0, 93184
    s_nop 0
    buffer_load_dwordx4 v29, s[20:23], s30 offen lds
    s_mov_b32 m0, 94208
    s_nop 0
    buffer_load_dwordx4 v30, s[20:23], s30 offen lds
    s_mov_b32 m0, 95232
    s_nop 0
    buffer_load_dwordx4 v31, s[20:23], s30 offen lds
    s_mov_b32 m0, 96256
    s_nop 0
    buffer_load_dwordx4 v32, s[20:23], s30 offen lds
    s_mov_b32 m0, 97280
    s_nop 0
    buffer_load_dwordx4 v33, s[20:23], s30 offen lds
    s_mov_b32 m0, 98304
    s_nop 0
    buffer_load_dwordx4 v34, s[20:23], s30 offen lds
    s_mov_b32 m0, 99328
    s_nop 0
    buffer_load_dwordx4 v35, s[20:23], s30 offen lds
    s_mov_b32 m0, 100352
    s_nop 0
    buffer_load_dwordx4 v36, s[12:15], s29 offen lds
    s_add_u32 s29, s29, 10240
    s_add_u32 s30, s30, 128
    s_add_u32 s44, s44, 1
    s_cmp_eq_u32 s44, 27
    s_cselect_b32 s44, 0, s44
    s_cselect_b32 s47, 276480, 0
    s_cselect_b32 s34, 3456, 0
    s_sub_u32 s29, s29, s47
    s_sub_u32 s30, s30, s34
    s_mov_b32 m0, 110592
    s_nop 0
    buffer_load_dwordx4 v28, s[20:23], s30 offen lds
    s_mov_b32 m0, 111616
    s_nop 0
    buffer_load_dwordx4 v29, s[20:23], s30 offen lds
    s_mov_b32 m0, 112640
    s_nop 0
    buffer_load_dwordx4 v30, s[20:23], s30 offen lds
    s_mov_b32 m0, 113664
    s_nop 0
    buffer_load_dwordx4 v31, s[20:23], s30 offen lds
    s_mov_b32 m0, 114688
    s_nop 0
    buffer_load_dwordx4 v32, s[20:23], s30 offen lds
    s_mov_b32 m0, 115712
    s_nop 0
    buffer_load_dwordx4 v33, s[20:23], s30 offen lds
    s_mov_b32 m0, 116736
    s_nop 0
    buffer_load_dwordx4 v34, s[20:23], s30 offen lds
    s_mov_b32 m0, 117760
    s_nop 0
    buffer_load_dwordx4 v35, s[20:23], s30 offen lds
    s_mov_b32 m0, 118784
    s_nop 0
    buffer_load_dwordx4 v36, s[12:15], s29 offen lds
    s_add_u32 s29, s29, 10240
    s_add_u32 s30, s30, 128
    s_add_u32 s44, s44, 1
    s_cmp_eq_u32 s44, 27
    s_cselect_b32 s44, 0, s44
    s_cselect_b32 s47, 276480, 0
    s_cselect_b32 s34, 3456, 0
    s_sub_u32 s29, s29, s47
    s_sub_u32 s30, s30, s34
    s_waitcnt vmcnt(54)
    s_barrier
    s_mov_b32 m0, 129024
    s_nop 0
    buffer_load_dwordx4 v28, s[20:23], s30 offen lds
    s_mov_b32 m0, 130048
    s_nop 0
    buffer_load_dwordx4 v29, s[20:23], s30 offen lds
    s_mov_b32 m0, 131072
    s_nop 0
    buffer_load_dwordx4 v30, s[20:23], s30 offen lds
    s_mov_b32 m0, 132096
    s_nop 0
    buffer_load_dwordx4 v31, s[20:23], s30 offen lds
    s_mov_b32 m0, 133120
    s_nop 0
    buffer_load_dwordx4 v32, s[20:23], s30 offen lds
    s_mov_b32 m0, 134144
    s_nop 0
    buffer_load_dwordx4 v33, s[20:23], s30 offen lds
    s_mov_b32 m0, 135168
    s_nop 0
    buffer_load_dwordx4 v34, s[20:23], s30 offen lds
    s_mov_b32 m0, 136192
    s_nop 0
    buffer_load_dwordx4 v35, s[20:23], s30 offen lds
    s_mov_b32 m0, 137216
    s_nop 0
    buffer_load_dwordx4 v36, s[12:15], s29 offen lds
    s_add_u32 s29, s29, 10240
    s_add_u32 s30, s30, 128
    s_add_u32 s44, s44, 1
    s_cmp_eq_u32 s44, 27
    s_cselect_b32 s44, 0, s44
    s_cselect_b32 s47, 276480, 0
    s_cselect_b32 s34, 3456, 0
    s_sub_u32 s29, s29, s47
    s_sub_u32 s30, s30, s34
    s_mov_b32 s36, 0
    s_mov_b32 s35, 0
k5_l0:
    s_waitcnt vmcnt(54)
    s_barrier
    s_add_u32 m0, s36, 0
    s_nop 0
    buffer_load_dwordx4 v28, s[20:23], s30 offen lds
    s_add_u32 m0, s36, 1024
    s_nop 0
    buffer_load_dwordx4 v29, s[20:23], s30 offen lds
    s_add_u32 m0, s36, 2048
    s_nop 0
    buffer_load_dwordx4 v30, s[20:23], s30 offen lds
    s_add_u32 m0, s36, 3072
    s_nop 0
    buffer_load_dwordx4 v31, s[20:23], s30 offen lds
    s_add_u32 m0, s36, 4096
    s_nop 0
    buffer_load_dwordx4 v32, s[20:23], s30 offen lds
    s_add_u32 m0, s36, 5120
    s_nop 0
    buffer_load_dwordx4 v33, s[20:23], s30 offen lds
    s_add_u32 m0, s36, 6144
    s_nop 0
    buffer_load_dwordx4 v34, s[20:23], s30 offen lds
    s_add_u32 m0, s36, 7168
    s_nop 0
    buffer_load_dwordx4 v35, s[20:23], s30 offen lds
    s_add_u32 m0, s36, 8192
    s_nop 0
    buffer_load_dwordx4 v36, s[12:15], s29 offen lds
    s_add_u32 s29, s29, 10240
    s_add_u32 s30, s30, 128
    s_add_u32 s44, s44, 1
    s_cmp_eq_u32 s44, 27
    s_cselect_b32 s44, 0, s44
    s_cselect_b32 s47, 276480, 0
    s_cselect_b32 s34, 3456, 0
    s_sub_u32 s29, s29, s47
    s_sub_u32 s30, s30, s34
    s_add_u32 s36, s36, 18432
    s_cmp_eq_u32 s36, 147456
    s_cselect_b32 s36, 0, s36
    s_add_u32 s35, s35, 1
    s_cmp_lt_u32 s35, 19
    s_cbranch_scc1 k5_l0
    s_waitcnt vmcnt(54)
    s_barrier
    s_waitcnt vmcnt(45)
    s_barrier
    s_waitcnt vmcnt(36)
    s_barrier
    s_waitcnt vmcnt(27)
    s_barrier
    s_waitcnt vmcnt(18)
    s_barrier
    s_waitcnt vmcnt(9)
    s_barrier
    s_waitcnt vmcnt(0)
    s_barrier
    s_endpgm
k5_p1:
    v_lshlrev_b32 v28, 4, v1
    v_add_u32 v28, 1024, v28
    v_lshlrev_b32 v29, 4, v1
    v_add_u32 v29, 2048, v29
    v_lshlrev_b32 v30, 4, v1
    v_add_u32 v30, 3072, v30
    v_lshlrev_b32 v31, 4, v1
    v_add_u32 v31, 4096, v31
    v_lshlrev_b32 v32, 4, v1
    v_add_u32 v32, 5120, v32
    v_lshlrev_b32 v33, 4, v1
    v_add_u32 v33, 6144, v33
    v_lshlrev_b32 v34, 4, v1
    v_add_u32 v34, 7168, v34
    v_lshlrev_b32 v35, 4, v1
    v_add_u32 v35, 8192, v35
    v_lshlrev_b32 v36, 4, v1
    v_add_u32 v36, 9216, v36
    s_mov_b32 m0, 9216
    s_nop 0
    buffer_load_dwordx4 v28, s[12:15], s29 offen lds
    s_mov_b32 m0, 10240
    s_nop 0
    buffer_load_dwordx4 v29, s[12:15], s29 offen lds
    s_mov_b32 m0, 11264
    s_nop 0
    buffer_load_dwordx4 v30, s[12:15], s29 offen lds
    s_mov_b32 m0, 12288
    s_nop 0
    buffer_load_dwordx4 v31, s[12:15], s29 offen lds
    s_mov_b32 m0, 13312
    s_nop 0
    buffer_load_dwordx4 v32, s[12:15], s29 offen lds
    s_mov_b32 m0, 14336
    s_nop 0
    buffer_load_dwordx4 v33, s[12:15], s29 offen lds
    s_mov_b32 m0, 15360
    s_nop 0
    buffer_load_dwordx4 v34, s[12:15], s29 offen lds
    s_mov_b32 m0, 16384
    s_nop 0
    buffer_load_dwordx4 v35, s[12:15], s29 offen lds
    s_mov_b32 m0, 17408
    s_nop 0
    buffer_load_dwordx4 v36, s[12:15], s29 offen lds
    s_add_u32 s29, s29, 10240
    s_add_u32 s30, s30, 128
    s_add_u32 s44, s44, 1
    s_cmp_eq_u32 s44, 27
    s_cselect_b32 s44, 0, s44
    s_cselect_b32 s47, 276480, 0
    s_cselect_b32 s34, 3456, 0
    s_sub_u32 s29, s29, s47
    s_sub_u32 s30, s30, s34
    s_mov_b32 m0, 27648
    s_nop 0
    buffer_load_dwordx4 v28, s[12:15], s29 offen lds
    s_mov_b32 m0, 28672
    s_nop 0
    buffer_load_dwordx4 v29, s[12:15], s29 offen lds
    s_mov_b32 m0, 29696
    s_nop 0
    buffer_load_dwordx4 v30, s[12:15], s29 offen lds
    s_mov_b32 m0, 30720
    s_nop 0
    buffer_load_dwordx4 v31, s[12:15], s29 offen lds
    s_mov_b32 m0, 31744
    s_nop 0
    buffer_load_dwordx4 v32, s[12:15], s29 offen lds
    s_mov_b32 m0, 32768
    s_nop 0
    buffer_load_dwordx4 v33, s[12:15], s29 offen lds
    s_mov_b32 m0, 33792
    s_nop 0
    buffer_load_dwordx4 v34, s[12:15], s29 offen lds
    s_mov_b32 m0, 34816
    s_nop 0
    buffer_load_dwordx4 v35, s[12:15], s29 offen lds
    s_mov_b32 m0, 35840
    s_nop 0
    buffer_load_dwordx4 v36, s[12:15], s29 offen lds
    s_add_u32 s29, s29, 10240
    s_add_u32 s30, s30, 128
    s_add_u32 s44, s44, 1
    s_cmp_eq_u32 s44, 27
    s_cselect_b32 s44, 0, s44
    s_cselect_b32 s47, 276480, 0
    s_cselect_b32 s34, 3456, 0
    s_sub_u32 s29, s29, s47
    s_sub_u32 s30, s30, s34
    s_mov_b32 m0, 46080
    s_nop 0
    buffer_load_dwordx4 v28, s[12:15], s29 offen lds
    s_mov_b32 m0, 47104
    s_nop 0
    buffer_load_dwordx4 v29, s[12:15], s29 offen lds
    s_mov_b32 m0, 48128
    s_nop 0
    buffer_load_dwordx4 v30, s[12:15], s29 offen lds
    s_mov_b32 m0, 49152
    s_nop 0
    buffer_load_dwordx4 v31, s[12:15], s29 offen lds
    s_mov_b32 m0, 50176
    s_nop 0
    buffer_load_dwordx4 v32, s[12:15], s29 offen lds
    s_mov_b32 m0, 51200
    s_nop 0
    buffer_load_dwordx4 v33, s[12:15], s29 offen lds
    s_mov_b32 m0, 52224
    s_nop 0
    buffer_load_dwordx4 v34, s[12:15], s29 offen lds
    s_mov_b32 m0, 53248
    s_nop 0
    buffer_load_dwordx4 v35, s[12:15], s29 offen lds
    s_mov_b32 m0, 54272
    s_nop 0
    buffer_load_dwordx4 v36, s[12:15], s29 offen lds
    s_add_u32 s29, s29, 10240
    s_add_u32 s30, s30, 128
    s_add_u32 s44, s44, 1
    s_cmp_eq_u32 s44, 27
    s_cselect_b32 s44, 0, s44
    s_cselect_b32 s47, 276480, 0
    s_cselect_b32 s34, 3456, 0
    s_sub_u32 s29, s29, s47
    s_sub_u32 s30, s30, s34
    s_mov_b32 m0, 64512
    s_nop 0
    buffer_load_dwordx4 v28, s[12:15], s29 offen lds
    s_mov_b32 m0, 65536
    s_nop 0
    buffer_load_dwordx4 v29, s[12:15], s29 offen lds
    s_mov_b32 m0, 66560
    s_nop 0
    buffer_load_dwordx4 v30, s[12:15], s29 offen lds
    s_mov_b32 m0, 67584
    s_nop 0
    buffer_load_dwordx4 v31, s[12:15], s29 offen lds
    s_mov_b32 m0, 68608
    s_nop 0
    buffer_load_dwordx4 v32, s[12:15], s29 offen lds
    s_mov_b32 m0, 69632
    s_nop 0
    buffer_load_dwordx4 v33, s[12:15], s29 offen lds
    s_mov_b32 m0, 70656
    s_nop 0
    buffer_load_dwordx4 v34, s[12:15], s29 offen lds
    s_mov_b32 m0, 71680
    s_nop 0
    buffer_load_dwordx4 v35, s[12:15], s29 offen lds
    s_mov_b32 m0, 72704
    s_nop 0
    buffer_load_dwordx4 v36, s[12:15], s29 offen lds
    s_add_u32 s29, s29, 10240
    s_add_u32 s30, s30, 128
    s_add_u32 s44, s44, 1
    s_cmp_eq_u32 s44, 27
    s_cselect_b32 s44, 0, s44
    s_cselect_b32 s47, 276480, 0
    s_cselect_b32 s34, 3456, 0
    s_sub_u32 s29, s29, s47
    s_sub_u32 s30, s30, s34
    s_mov_b32 m0, 82944
    s_nop 0
    buffer_load_dwordx4 v28, s[12:15], s29 offen lds
    s_mov_b32 m0, 83968
    s_nop 0
    buffer_load_dwordx4 v29, s[12:15], s29 offen lds
    s_mov_b32 m0, 84992
    s_nop 0
    buffer_load_dwordx4 v30, s[12:15], s29 offen lds
    s_mov_b32 m0, 86016
    s_nop 0
    buffer_load_dwordx4 v31, s[12:15], s29 offen lds
    s_mov_b32 m0, 87040
    s_nop 0
    buffer_load_dwordx4 v32, s[12:15], s29 offen lds
    s_mov_b32 m0, 88064
    s_nop 0
    buffer_load_dwordx4 v33, s[12:15], s29 offen lds
    s_mov_b32 m0, 89088
    s_nop 0
    buffer_load_dwordx4 v34, s[12:15], s29 offen lds
    s_mov_b32 m0, 90112
    s_nop 0
    buffer_load_dwordx4 v35, s[12:15], s29 offen lds
    s_mov_b32 m0, 91136
    s_nop 0
    buffer_load_dwordx4 v36, s[12:15], s29 offen lds
    s_add_u32 s29, s29, 10240
    s_add_u32 s30, s30, 128
    s_add_u32 s44, s44, 1
    s_cmp_eq_u32 s44, 27
    s_cselect_b32 s44, 0, s44
    s_cselect_b32 s47, 276480, 0
    s_cselect_b32 s34, 3456, 0
    s_sub_u32 s29, s29, s47
    s_sub_u32 s30, s30, s34
    s_mov_b32 m0, 101376
    s_nop 0
    buffer_load_dwordx4 v28, s[12:15], s29 offen lds
    s_mov_b32 m0, 102400
    s_nop 0
    buffer_load_dwordx4 v29, s[12:15], s29 offen lds
    s_mov_b32 m0, 103424
    s_nop 0
    buffer_load_dwordx4 v30, s[12:15], s29 offen lds
    s_mov_b32 m0, 104448
    s_nop 0
    buffer_load_dwordx4 v31, s[12:15], s29 offen lds
    s_mov_b32 m0, 105472
    s_nop 0
    buffer_load_dwordx4 v32, s[12:15], s29 offen lds
    s_mov_b32 m0, 106496
    s_nop 0
    buffer_load_dwordx4 v33, s[12:15], s29 offen lds
    s_mov_b32 m0, 107520
    s_nop 0
    buffer_load_dwordx4 v34, s[12:15], s29 offen lds
    s_mov_b32 m0, 108544
    s_nop 0
    buffer_load_dwordx4 v35, s[12:15], s29 offen lds
    s_mov_b32 m0, 109568
    s_nop 0
    buffer_load_dwordx4 v36, s[12:15], s29 offen lds
    s_add_u32 s29, s29, 10240
    s_add_u32 s30, s30, 128
    s_add_u32 s44, s44, 1
    s_cmp_eq_u32 s44, 27
    s_cselect_b32 s44, 0, s44
    s_cselect_b32 s47, 276480, 0
    s_cselect_b32 s34, 3456, 0
    s_sub_u32 s29, s29, s47
    s_sub_u32 s30, s30, s34
    s_mov_b32 m0, 119808
    s_nop 0
    buffer_load_dwordx4 v28, s[12:15], s29 offen lds
    s_mov_b32 m0, 120832
    s_nop 0
    buffer_load_dwordx4 v29, s[12:15], s29 offen lds
    s_mov_b32 m0, 121856
    s_nop 0
    buffer_load_dwordx4 v30, s[12:15], s29 offen lds
    s_mov_b32 m0, 122880
    s_nop 0
    buffer_load_dwordx4 v31, s[12:15], s29 offen lds
    s_mov_b32 m0, 123904
    s_nop 0
    buffer_load_dwordx4 v32, s[12:15], s29 offen lds
    s_mov_b32 m0, 124928
    s_nop 0
    buffer_load_dwordx4 v33, s[12:15], s29 offen lds
    s_mov_b32 m0, 125952
    s_nop 0
    buffer_load_dwordx4 v34, s[12:15], s29 offen lds
    s_mov_b32 m0, 126976
    s_nop 0
    buffer_load_dwordx4 v35, s[12:15], s29 offen lds
    s_mov_b32 m0, 128000
    s_nop 0
    buffer_load_dwordx4 v36, s[12:15], s29 offen lds
    s_add_u32 s29, s29, 10240
    s_add_u32 s30, s30, 128
    s_add_u32 s44, s44, 1
    s_cmp_eq_u32 s44, 27
    s_cselect_b32 s44, 0, s44
    s_cselect_b32 s47, 276480, 0
    s_cselect_b32 s34, 3456, 0
    s_sub_u32 s29, s29, s47
    s_sub_u32 s30, s30, s34
    s_waitcnt vmcnt(54)
    s_barrier
    s_mov_b32 m0, 138240
    s_nop 0
    buffer_load_dwordx4 v28, s[12:15], s29 offen lds
    s_mov_b32 m0, 139264
    s_nop 0
    buffer_load_dwordx4 v29, s[12:15], s29 offen lds
    s_mov_b32 m0, 140288
    s_nop 0
    buffer_load_dwordx4 v30, s[12:15], s29 offen lds
    s_mov_b32 m0, 141312
    s_nop 0
    buffer_load_dwordx4 v31, s[12:15], s29 offen lds
    s_mov_b32 m0, 142336
    s_nop 0
    buffer_load_dwordx4 v32, s[12:15], s29 offen lds
    s_mov_b32 m0, 143360
    s_nop 0
    buffer_load_dwordx4 v33, s[12:15], s29 offen lds
    s_mov_b32 m0, 144384
    s_nop 0
    buffer_load_dwordx4 v34, s[12:15], s29 offen lds
    s_mov_b32 m0, 145408
    s_nop 0
    buffer_load_dwordx4 v35, s[12:15], s29 offen lds
    s_mov_b32 m0, 146432
    s_nop 0
    buffer_load_dwordx4 v36, s[12:15], s29 offen lds
    s_add_u32 s29, s29, 10240
    s_add_u32 s30, s30, 128
    s_add_u32 s44, s44, 1
    s_cmp_eq_u32 s44, 27
    s_cselect_b32 s44, 0, s44
    s_cselect_b32 s47, 276480, 0
    s_cselect_b32 s34, 3456, 0
    s_sub_u32 s29, s29, s47
    s_sub_u32 s30, s30, s34
    s_mov_b32 s36, 0
    s_mov_b32 s35, 0
k5_l1:
    s_waitcnt vmcnt(54)
    s_barrier
    s_add_u32 m0, s36, 9216
    s_nop 0
    buffer_load_dwordx4 v28, s[12:15], s29 offen lds
    s_add_u32 m0, s36, 10240
    s_nop 0
    buffer_load_dwordx4 v29, s[12:15], s29 offen lds
    s_add_u32 m0, s36, 11264
    s_nop 0
    buffer_load_dwordx4 v30, s[12:15], s29 offen lds
    s_add_u32 m0, s36, 12288
    s_nop 0
    buffer_load_dwordx4 v31, s[12:15], s29 offen lds
    s_add_u32 m0, s36, 13312
    s_nop 0
    buffer_load_dwordx4 v32, s[12:15], s29 offen lds
    s_add_u32 m0, s36, 14336
    s_nop 0
    buffer_load_dwordx4 v33, s[12:15], s29 offen lds
    s_add_u32 m0, s36, 15360
    s_nop 0
    buffer_load_dwordx4 v34, s[12:15], s29 offen lds
    s_add_u32 m0, s36, 16384
    s_nop 0
    buffer_load_dwordx4 v35, s[12:15], s29 offen lds
    s_add_u32 m0, s36, 17408
    s_nop 0
    buffer_load_dwordx4 v36, s[12:15], s29 offen lds
    s_add_u32 s29, s29, 10240
    s_add_u32 s30, s30, 128
    s_add_u32 s44, s44, 1
    s_cmp_eq_u32 s44, 27
    s_cselect_b32 s44, 0, s44
    s_cselect_b32 s47, 276480, 0
    s_cselect_b32 s34, 3456, 0
    s_sub_u32 s29, s29, s47
    s_sub_u32 s30, s30, s34
    s_add_u32 s36, s36, 18432
    s_cmp_eq_u32 s36, 147456
    s_cselect_b32 s36, 0, s36
    s_add_u32 s35, s35, 1
    s_cmp_lt_u32 s35, 19
    s_cbranch_scc1 k5_l1
    s_waitcnt vmcnt(54)
    s_barrier
    s_waitcnt vmcnt(45)
    s_barrier
    s_waitcnt vmcnt(36)
    s_barrier
    s_waitcnt vmcnt(27)
    s_barrier
    s_waitcnt vmcnt(18)
    s_barrier
    s_waitcnt vmcnt(9)
    s_barrier
    s_waitcnt vmcnt(0)
    s_barrier
    s_endpgm
k5_end:
    s_endpgm
.section .rodata,"a"
.p2align 6
.amdhsa_kernel k1_kernel
  .amdhsa_next_free_vgpr 160
  .amdhsa_next_free_sgpr 60
  .amdhsa_accum_offset 160
  .amdhsa_group_segment_fixed_size 0
  .amdhsa_kernarg_size 80
  .amdhsa_user_sgpr_count 2
  .amdhsa_user_sgpr_kernarg_segment_ptr 1
  .amdhsa_system_sgpr_workgroup_id_x 1
.end_amdhsa_kernel
.p2align 6
.amdhsa_kernel k2_kernel
  .amdhsa_next_free_vgpr 200
  .amdhsa_next_free_sgpr 40
  .amdhsa_accum_offset 200
  .amdhsa_group_segment_fixed_size 0
  .amdhsa_kernarg_size 80
  .amdhsa_user_sgpr_count 2
  .amdhsa_user_sgpr_kernarg_segment_ptr 1
  .amdhsa_system_sgpr_workgroup_id_x 1
.end_amdhsa_kernel
.p2align 6
.amdhsa_kernel k3_kernel
  .amdhsa_next_free_vgpr 172
  .amdhsa_next_free_sgpr 60
  .amdhsa_accum_offset 172
  .amdhsa_group_segment_fixed_size 0
  .amdhsa_kernarg_size 80
  .amdhsa_user_sgpr_count 2
  .amdhsa_user_sgpr_kernarg_segment_ptr 1
  .amdhsa_system_sgpr_workgroup_id_x 1
.end_amdhsa_kernel
.p2align 6
.amdhsa_kernel k4_kernel
  .amdhsa_next_free_vgpr 148
  .amdhsa_next_free_sgpr 48
  .amdhsa_accum_offset 148
  .amdhsa_group_segment_fixed_size 0
  .amdhsa_kernarg_size 80
  .amdhsa_user_sgpr_count 2
  .amdhsa_user_sgpr_kernarg_segment_ptr 1
  .amdhsa_system_sgpr_workgroup_id_x 1
.end_amdhsa_kernel
.p2align 6
.amdhsa_kernel k5_kernel
  .amdhsa_next_free_vgpr 124
  .amdhsa_next_free_sgpr 48
  .amdhsa_accum_offset 124
  .amdhsa_group_segment_fixed_size 0
  .amdhsa_kernarg_size 80
  .amdhsa_user_sgpr_count 2
  .amdhsa_user_sgpr_kernarg_segment_ptr 1
  .amdhsa_system_sgpr_workgroup_id_x 1
.end_amdhsa_kernel
```
